```python
import torch

def _softmax(x, axis=-1):
    return torch.softmax(x, dim=axis)
def _gelu(x):
    return torch.nn.functional.gelu(x, approximate="tanh")
def _silu(x):
    return torch.nn.functional.silu(x)
def _sigmoid(x):
    return torch.sigmoid(x)
def _layernorm(x, axis=-1, eps=1e-5):
    m = x.mean(dim=axis, keepdim=True)
    v = x.var(dim=axis, keepdim=True, unbiased=False)
    return (x - m) / torch.sqrt(v + eps)
def _scatter_add(tgt, idx, src, axis=0):
    return tgt.clone().index_add_(axis, idx, src)
def _segment_sum(src, seg, n):
    out = torch.zeros((n,) + src.shape[1:], dtype=src.dtype)
    return out.index_add_(0, seg, src)
def _pad(x, pw):
    flat = tuple(v for pair in reversed(pw) for v in pair)
    return torch.nn.functional.pad(x, flat)

kernel_name = 'gated_mix__ssm_conv_s5__grouped_kv_mqa__prompt'

def setup_inputs():

    _w = (lambda a: (lambda t: t.to(torch.bfloat16) if t.is_floating_point() else t)(torch.as_tensor(a)))
    def _A_setup():
        B, S, D = 1, 2048, 576
        P = D
        Lambda_re = -0.5 * (lambda _x: torch.exp(torch.as_tensor(_x)))((lambda *s: torch.randn(*s, dtype=torch.bfloat16) * 0.2)(P))
        Lambda_im = (lambda *s: torch.randn(*s, dtype=torch.bfloat16) * 0.4)(P) * 1.0
        B_re = (lambda *s: torch.randn(*s, dtype=torch.bfloat16) * 0.2)(P, D) * (D ** -0.5)
        B_im = (lambda *s: torch.randn(*s, dtype=torch.bfloat16) * 0.2)(P, D) * (D ** -0.5)
        C_re = (lambda *s: torch.randn(*s, dtype=torch.bfloat16) * 0.2)(D, P) * (P ** -0.5)
        C_im = (lambda *s: torch.randn(*s, dtype=torch.bfloat16) * 0.2)(D, P) * (P ** -0.5)
        log_dt = (lambda *s: torch.randn(*s, dtype=torch.bfloat16) * 0.2)(P) * 0.3 - 2.0
        Dskip = (lambda *s: torch.randn(*s, dtype=torch.bfloat16) * 0.05)(D)
        return {
            "x": _w((lambda *s: torch.randn(*s, dtype=torch.bfloat16) * 0.05)(B, S, D)),
            "Lambda_re": _w(Lambda_re),
            "Lambda_im": _w(Lambda_im),
            "B_re": _w(B_re),
            "B_im": _w(B_im),
            "C_re": _w(C_re),
            "C_im": _w(C_im),
            "log_dt": _w(log_dt),
            "Dskip": _w(Dskip),
        }
    _A_in = _A_setup()

    def _B_setup():
        B, S, D, H = 1, 2048, 576, 32
        Dh = D // H
        return {
            "x": _w((lambda *s: torch.randn(*s, dtype=torch.bfloat16) * 0.05)(B, S, D)),
            "wq": _w((lambda *s: torch.randn(*s, dtype=torch.bfloat16) * 0.8)(D, H * Dh)),
            "wk": _w((lambda *s: torch.randn(*s, dtype=torch.bfloat16) * 0.8)(D, Dh)),
            "wv": _w((lambda *s: torch.randn(*s, dtype=torch.bfloat16) * 0.05)(D, Dh)),
            "wo": _w((lambda *s: torch.randn(*s, dtype=torch.bfloat16) * 0.05)(H * Dh, D)),
        }
    _B_in = _B_setup()

    return {
        "A_x": _A_in["x"],
        "A_Lambda_re": _A_in["Lambda_re"],
        "A_Lambda_im": _A_in["Lambda_im"],
        "A_B_re": _A_in["B_re"],
        "A_B_im": _A_in["B_im"],
        "A_C_re": _A_in["C_re"],
        "A_C_im": _A_in["C_im"],
        "A_log_dt": _A_in["log_dt"],
        "A_Dskip": _A_in["Dskip"],
        "B_x": _B_in["x"],
        "B_wq": _B_in["wq"],
        "B_wk": _B_in["wk"],
        "B_wv": _B_in["wv"],
        "B_wo": _B_in["wo"],
        "gate_w": _w((lambda *s: torch.randn(*s, dtype=torch.bfloat16) * 0.05)(576) * 16.0),
    }

def reference(A_x, A_Lambda_re, A_Lambda_im, A_B_re, A_B_im, A_C_re, A_C_im, A_log_dt, A_Dskip, B_x, B_wq, B_wk, B_wv, B_wo, gate_w):
    def _A_ref(x, Lambda_re, Lambda_im, B_re, B_im, C_re, C_im, log_dt, Dskip):
        Bsz, L, H = x.shape
        Lam = Lambda_re + 1j * Lambda_im
        Bmat = B_re + 1j * B_im
        Cmat = C_re + 1j * C_im
        dt = torch.exp(log_dt)
        Lam_bar = torch.exp(dt * Lam)
        B_bar = ((Lam_bar - 1.0) / Lam)[:, None] * Bmat
        Bu = torch.einsum("bld,pd->blp", x + 0j, B_bar)
        h = torch.zeros_like(Bu[:, 0, :])
        hs = []
        for t in range(L):
            h = Lam_bar[None, :] * h + Bu[:, t, :]
            hs.append(h)
        hseq = torch.stack(hs, 1)
        y = 2.0 * torch.einsum("blp,dp->bld", hseq, Cmat).real + x * Dskip[None, None, :]
        return y

    def _B_ref(x, wq, wk, wv, wo):
        B, S, D = x.shape
        H = 32
        Dh = D // H
        q = (lambda x, *d: x.permute(*d))((x @ wq).reshape(B, S, H, Dh), 0, 2, 1, 3)
        k = x @ wk
        v = x @ wv
        scores = torch.einsum("bhqd,bkd->bhqk", q, k) * (Dh ** -0.5)
        p = _softmax(scores, axis=-1)
        o = torch.einsum("bhqk,bkd->bhqd", p, v)
        return (lambda x, *d: x.permute(*d))(o, 0, 2, 1, 3).reshape(B, S, H * Dh) @ wo

    x = A_x
    g = _sigmoid((x * gate_w).sum(-1, keepdims=True))
    a = _A_ref(x, A_Lambda_re, A_Lambda_im, A_B_re, A_B_im, A_C_re, A_C_im, A_log_dt, A_Dskip)
    b = _B_ref(x, B_wq, B_wk, B_wv, B_wo)
    return g * a + (1 - g) * b
```

```asm
; @launch grid=(256,1,1) block=(768,1,1) lds=163840
.amdgcn_target "amdgcn-amd-amdhsa--gfx950"
.text
.globl gated_mix__ssm_conv_s5__grouped_kv_mqa__prompt_kernel
.p2align 8
.type gated_mix__ssm_conv_s5__grouped_kv_mqa__prompt_kernel,@function
gated_mix__ssm_conv_s5__grouped_kv_mqa__prompt_kernel:
    s_cmp_ge_u32 s2, 256
    s_cbranch_scc1 F_EXIT
    s_load_dwordx16 s[36:51], s[0:1], 0
    s_load_dwordx16 s[52:67], s[0:1], 64
    s_load_dwordx4 s[68:71], s[0:1], 128
    s_bfe_u32 s3, s2, 0x20001
    s_lshr_b32 s4, s2, 5
    s_lshl_b32 s3, s3, 3
    s_add_u32 s4, s4, s3
    s_bfe_u32 s5, s2, 0x20003
    s_lshl_b32 s5, s5, 1
    s_and_b32 s3, s2, 1
    s_add_u32 s5, s5, s3
    v_lshrrev_b32 v1, 6, v0
    v_and_b32 v0, 63, v0
    v_readfirstlane_b32 s6, v1
    s_mov_b32 s72, 0x40000
    s_mul_i32 s74, s4, 57
    s_lshr_b32 s74, s74, 9
    s_mul_i32 s74, s74, 9
    s_sub_u32 s74, s4, s74
    v_lshlrev_b32 v1, 4, v0
    v_mov_b32 v2, 156672
    v_mov_b32 v3, 1
    v_mov_b32 v16, 0
    v_mov_b32 v17, 0
    v_lshl_add_u32 v8, v0, 2, v2
    v_mov_b32 v9, 0
    s_mov_b64 exec, 4
    v_mov_b32 v9, 0xfc00
    s_mov_b64 exec, 8
    v_mov_b32 v9, 0x10000
    s_mov_b64 exec, -1
    ds_write_b32 v8, v9
    s_sub_u32 s7, s6, 4
    s_xor_b32 s8, s7, 2
    s_cmp_lt_u32 s6, 8
    s_cselect_b32 s7, s8, s7
    s_and_b32 s8, s5, 6
    s_add_u32 s7, s7, s8
    s_and_b32 s7, s7, 7
    s_cmp_lt_u32 s6, 4
    s_cselect_b32 s7, s5, s7
    v_lshrrev_b32 v5, 3, v0
    v_and_b32 v7, 7, v0
    v_lshrrev_b32 v8, 1, v5
    s_and_b32 s8, s7, 1
    s_lshl_b32 s8, s8, 2
    v_or_b32 v8, s8, v8
    v_xor_b32 v7, v7, v8
    v_lshlrev_b32 v7, 4, v7
    v_lshrrev_b32 v8, 2, v5
    v_and_b32 v5, 3, v5
    v_lshl_add_u32 v5, v8, 4, v5
    s_lshl_b32 s8, s4, 6
    s_lshr_b32 s9, s7, 2
    s_lshl_b32 s9, s9, 5
    s_add_u32 s8, s8, s9
    s_and_b32 s9, s7, 3
    s_lshl_b32 s9, s9, 2
    s_add_u32 s8, s8, s9
    v_add_u32 v5, s8, v5
    v_mul_u32_u24 v6, 1152, v5
    v_add_u32 v6, v6, v7
    s_lshl_b32 s9, s7, 10
    s_add_u32 s9, s9, 82944
    s_lshl_b32 s10, s74, 7
    s_lshl_b32 s24, s6, 6
    v_add_u32 v23, s24, v0
    v_mul_u32_u24 v19, 21846, v23
    v_lshrrev_b32 v19, 16, v19
    v_mul_u32_u24 v24, 3, v19
    v_sub_u32 v24, v23, v24
    v_lshlrev_b32 v24, 4, v24
    v_min_u32 v24, 20, v24
    v_mad_u32_u24 v19, v19, 36, v24
    s_cmp_lt_u32 s6, 3
    s_cselect_b64 vcc, -1, 0
    s_movk_i32 s17, 128
    s_cselect_b32 s17, 2304, s17
    s_movk_i32 s18, 1152
    s_cselect_b32 s18, 20736, s18
    s_movk_i32 s19, 0x2000
    s_cselect_b32 s19, 3072, s19
    s_mul_i32 s20, s74, s17
    s_lshl_b32 s16, s6, 10
    s_add_u32 s16, s16, 55296
    v_cndmask_b32 v19, v6, v19, vcc
    s_cmp_lt_u32 s6, 3
    s_cselect_b32 s16, s16, s9
    s_bitcmp1_b32 0xc7, s6
    s_cselect_b32 s21, 1, 0
    s_cselect_b32 s22, 2, 0
    s_waitcnt lgkmcnt(0)
    s_bitcmp1_b32 s5, 0
    s_cselect_b32 s12, s60, s58
    s_cselect_b32 s13, s61, s59
    s_cmp_lt_u32 s6, 3
    s_cselect_b32 s12, s12, s36
    s_cselect_b32 s13, s13, s37
    s_mov_b32 s14, 2359296
    s_cselect_b32 s14, 20736, s14
    s_mov_b32 s15, 0x20000
    s_cmp_eq_u32 s21, 1
    s_cbranch_scc1 F_DMA
    s_lshl_b32 s24, s6, 7
    s_and_b32 s24, s24, 0x1ff
    v_add_u32 v20, s24, v0
    v_add_u32 v21, 64, v20
    s_mul_i32 s25, s5, 144
    v_mul_u32_u24 v23, 7282, v20
    v_lshrrev_b32 v23, 16, v23
    v_mul_u32_u24 v24, 9, v23
    v_sub_u32 v24, v20, v24
    v_and_b32 v25, 48, v23
    v_and_b32 v26, 3, v23
    v_lshl_or_b32 v25, v26, 2, v25
    v_bfe_u32 v26, v23, 2, 2
    v_or_b32 v25, v25, v26
    v_mul_u32_u24 v25, 1152, v25
    v_lshl_add_u32 v25, v24, 4, v25
    v_add_u32 v16, s25, v25
    v_mul_u32_u24 v23, 7282, v21
    v_lshrrev_b32 v23, 16, v23
    v_mul_u32_u24 v24, 9, v23
    v_sub_u32 v24, v21, v24
    v_and_b32 v25, 48, v23
    v_and_b32 v26, 3, v23
    v_lshl_or_b32 v25, v26, 2, v25
    v_bfe_u32 v26, v23, 2, 2
    v_or_b32 v25, v25, v26
    v_mul_u32_u24 v25, 1152, v25
    v_lshl_add_u32 v25, v24, 4, v25
    v_add_u32 v17, s25, v25
    s_barrier
    s_cmp_lg_u32 s6, 3
    s_cbranch_scc1 F_DMA
    s_mov_b32 s16, s56
    s_mov_b32 s17, s57
    s_mov_b32 s18, 663552
    s_mov_b32 s19, 0x20000
    s_mul_i32 s25, s2, 2592
    v_lshlrev_b32 v40, 7, v0
    s_mov_b64 exec, 0x3fffff
    buffer_load_dword v41, v40, s[16:19], s25 offen
    s_mov_b64 exec, -1
    s_branch F_GATE
F_DMA:
    s_mov_b32 m0, s16
    s_add_u32 s16, s16, s19
    buffer_load_dwordx4 v19, s[12:15], s20 offen lds
    s_add_u32 s20, s20, s17
    s_cmp_eq_u32 s20, s18
    s_cselect_b32 s20, 0, s20
    s_mov_b32 m0, s16
    s_add_u32 s16, s16, s19
    buffer_load_dwordx4 v19, s[12:15], s20 offen lds
    s_add_u32 s20, s20, s17
    s_cmp_eq_u32 s20, s18
    s_cselect_b32 s20, 0, s20
    s_mov_b32 m0, s16
    s_add_u32 s16, s16, s19
    buffer_load_dwordx4 v19, s[12:15], s20 offen lds
    s_add_u32 s20, s20, s17
    s_cmp_eq_u32 s20, s18
    s_cselect_b32 s20, 0, s20
    s_mov_b32 m0, s16
    s_add_u32 s16, s16, s19
    buffer_load_dwordx4 v19, s[12:15], s20 offen lds
    s_add_u32 s20, s20, s17
    s_cmp_eq_u32 s20, s18
    s_cselect_b32 s20, 0, s20
    s_mov_b32 m0, s16
    s_add_u32 s16, s16, s19
    buffer_load_dwordx4 v19, s[12:15], s20 offen lds
    s_add_u32 s20, s20, s17
    s_cmp_eq_u32 s20, s18
    s_cselect_b32 s20, 0, s20
    s_mov_b32 m0, s16
    s_add_u32 s16, s16, s19
    buffer_load_dwordx4 v19, s[12:15], s20 offen lds
    s_add_u32 s20, s20, s17
    s_cmp_eq_u32 s20, s18
    s_cselect_b32 s20, 0, s20
    s_mov_b32 m0, s16
    s_add_u32 s16, s16, s19
    buffer_load_dwordx4 v19, s[12:15], s20 offen lds
    s_add_u32 s20, s20, s17
    s_cmp_eq_u32 s20, s18
    s_cselect_b32 s20, 0, s20
    s_mov_b32 m0, s16
    s_add_u32 s16, s16, s19
    buffer_load_dwordx4 v19, s[12:15], s20 offen lds
    s_add_u32 s20, s20, s17
    s_cmp_eq_u32 s20, s18
    s_cselect_b32 s20, 0, s20
    s_mov_b32 m0, s16
    s_add_u32 s16, s16, s19
    buffer_load_dwordx4 v19, s[12:15], s20 offen lds
    s_add_u32 s20, s20, s17
    s_cmp_eq_u32 s20, s18
    s_cselect_b32 s20, 0, s20
    s_mov_b32 s32, s70
    s_mov_b32 s33, s71
    s_mov_b32 s34, 12582912
    s_mov_b32 s35, 0x20000
    s_cmp_eq_u32 s21, 1
    s_cbranch_scc1 F_CRIT
    s_cmp_lt_u32 s6, 8
    s_cbranch_scc1 F_EX
    s_setprio 2
    s_sub_u32 s7, s6, 8
    s_lshr_b32 s100, s5, 1
    s_and_b32 s101, s5, 1
    s_lshl_b32 s101, s101, 2
    s_add_u32 s100, s100, s101
    s_xor_b32 s101, s100, 4
    s_mov_b32 s75, s100
    s_lshl_b32 s8, s5, 2
    s_add_u32 s8, s8, s7
    s_and_b32 s11, s100, 3
    s_add_u32 s11, s11, 32
    s_mov_b32 s16, s56
    s_mov_b32 s17, s57
    s_mov_b32 s18, 663552
    s_mov_b32 s19, 0x20000
    s_lshl_b32 s9, s7, 11
    s_mul_i32 s10, s74, 73728
    s_mul_i32 s3, s7, 1152
    s_add_u32 s3, s3, 156928
    s_setprio 1
    s_waitcnt vmcnt(4)
    s_add_u32 m0, s9, 0
    s_nop 0
    buffer_load_dwordx4 v16, s[16:19], s10 offen lds
    s_add_u32 m0, s9, 1024
    s_nop 0
    buffer_load_dwordx4 v17, s[16:19], s10 offen lds
    s_add_u32 s10, s10, 73728
    s_cmp_eq_u32 s10, 663552
    s_cselect_b32 s10, 0, s10
    s_waitcnt vmcnt(4)
    s_add_u32 m0, s9, 9216
    s_nop 0
    buffer_load_dwordx4 v16, s[16:19], s10 offen lds
    s_add_u32 m0, s9, 10240
    s_nop 0
    buffer_load_dwordx4 v17, s[16:19], s10 offen lds
    s_add_u32 s10, s10, 73728
    s_cmp_eq_u32 s10, 663552
    s_cselect_b32 s10, 0, s10
    s_add_u32 m0, s9, 18432
    s_nop 0
    buffer_load_dwordx4 v16, s[16:19], s10 offen lds
    s_add_u32 m0, s9, 19456
    s_nop 0
    buffer_load_dwordx4 v17, s[16:19], s10 offen lds
    s_add_u32 s10, s10, 73728
    s_cmp_eq_u32 s10, 663552
    s_cselect_b32 s10, 0, s10
    s_mov_b32 s31, 0
    s_mov_b32 s30, 0
    s_cmp_lt_u32 s75, 4
    s_cbranch_scc1 S_PR0
    s_lshl_b32 s27, s4, 2
    s_add_u32 s27, s27, s75
    s_sub_u32 s27, s27, 4
    s_mov_b32 s31, 1
    s_mul_i32 s29, s27, 7282
    s_lshr_b32 s29, s29, 16
    s_mul_i32 s30, s29, 9
    s_sub_u32 s30, s27, s30
    s_cmp_lt_u32 s27, 81
    s_cbranch_scc1 S_PR0
    s_sub_u32 s27, s27, 81
    s_lshl_b32 s27, s27, 2
    s_add_u32 s27, s27, s7
    s_mul_i32 s29, s27, 3641
    s_lshr_b32 s29, s29, 16
    s_mul_i32 s30, s29, 18
    s_sub_u32 s30, s27, s30
    s_cmp_lt_u32 s27, 162
    s_cselect_b32 s31, 2, 0
S_PR0:
    v_and_b32 v27, 15, v0
    v_lshlrev_b32 v28, 1, v27
    s_lshl_b32 s12, s8, 5
    s_lshl_b32 s13, s30, 2
    s_add_u32 s13, s13, s7
    s_cmp_eq_u32 s31, 1
    s_cselect_b32 s13, s13, s11
    s_lshl_b32 s13, s13, 5
    s_mov_b32 s20, s38
    s_mov_b32 s21, s39
    s_mov_b32 s22, 1152
    s_mov_b32 s23, 0x20000
    buffer_load_ushort v32, v28, s[20:23], s12 offen
    buffer_load_ushort v36, v28, s[20:23], s13 offen
    s_mov_b32 s20, s40
    s_mov_b32 s21, s41
    s_mov_b32 s22, 1152
    s_mov_b32 s23, 0x20000
    buffer_load_ushort v33, v28, s[20:23], s12 offen
    buffer_load_ushort v37, v28, s[20:23], s13 offen
    s_mov_b32 s20, s50
    s_mov_b32 s21, s51
    s_mov_b32 s22, 1152
    s_mov_b32 s23, 0x20000
    buffer_load_ushort v34, v28, s[20:23], s12 offen
    buffer_load_ushort v38, v28, s[20:23], s13 offen
    s_mov_b32 s20, s52
    s_mov_b32 s21, s53
    s_mov_b32 s22, 1152
    s_mov_b32 s23, 0x20000
    v_and_b32 v28, 31, v0
    v_lshlrev_b32 v28, 1, v28
    s_and_b32 s12, s7, 1
    s_lshl_b32 s13, s5, 1
    s_add_u32 s12, s12, s13
    s_lshl_b32 s12, s12, 6
    s_lshr_b32 s13, s101, 1
    s_add_u32 s13, s13, 14
    s_lshl_b32 s13, s13, 6
    buffer_load_ushort v35, v28, s[20:23], s12 offen
    buffer_load_ushort v39, v28, s[20:23], s13 offen
    s_waitcnt vmcnt(10)
    s_mov_b64 exec, 1
    ds_add_u32 v2, v3 offset:208
    s_mov_b64 exec, -1
    s_add_u32 m0, s9, 27648
    s_nop 0
    buffer_load_dwordx4 v16, s[16:19], s10 offen lds
    s_add_u32 m0, s9, 28672
    s_nop 0
    buffer_load_dwordx4 v17, s[16:19], s10 offen lds
    s_add_u32 s10, s10, 73728
    s_cmp_eq_u32 s10, 663552
    s_cselect_b32 s10, 0, s10
    v_and_b32 v12, 31, v0
    v_lshrrev_b32 v13, 5, v0
    v_bfe_u32 v14, v0, 1, 3
    v_xor_b32 v14, v14, v13
    v_lshlrev_b32 v14, 4, v14
    v_lshl_add_u32 v14, v12, 7, v14
    v_add_u32 v8, 82944, v14
    v_xor_b32 v9, 32, v8
    v_xor_b32 v10, 64, v8
    v_xor_b32 v11, 0x60, v8
    v_bfe_u32 v12, v0, 2, 3
    v_mul_u32_u24 v12, 144, v12
    v_lshl_add_u32 v12, v13, 6, v12
    v_mul_u32_u24 v20, 73728, v13
    v_and_b32 v13, 3, v0
    v_lshl_add_u32 v12, v13, 2, v12
    v_add_u32 v13, s3, v12
    v_lshrrev_b32 v12, 3, v0
    v_mul_u32_u24 v14, 144, v12
    v_and_b32 v21, 7, v0
    v_lshl_add_u32 v14, v21, 4, v14
    v_add_u32 v14, s3, v14
    v_and_b32 v12, 3, v12
    v_lshl_add_u32 v20, v12, 9, v20
    v_lshl_add_u32 v15, v21, 4, v20
    v_lshl_add_u32 v6, v27, 3, s3
    v_lshrrev_b32 v20, 4, v0
    v_lshl_add_u32 v12, v20, 7, v6
    v_bfe_u32 v21, v0, 4, 1
    v_lshrrev_b32 v22, 5, v0
    v_lshl_add_u32 v21, v21, 1, v22
    v_lshl_add_u32 v5, v21, 7, v6
    v_lshlrev_b32 v20, 11, v20
    v_sub_u32 v20, 6144, v20
    v_lshl_add_u32 v7, v27, 4, v20
    s_waitcnt vmcnt(4)
    s_add_u32 m0, s9, 36864
    s_nop 0
    buffer_load_dwordx4 v16, s[16:19], s10 offen lds
    s_add_u32 m0, s9, 37888
    s_nop 0
    buffer_load_dwordx4 v17, s[16:19], s10 offen lds
    s_add_u32 s10, s10, 73728
    s_cmp_eq_u32 s10, 663552
    s_cselect_b32 s10, 0, s10
    s_waitcnt vmcnt(4)
    v_lshlrev_b32 v32, 16, v32
    v_lshlrev_b32 v33, 16, v33
    v_lshlrev_b32 v34, 16, v34
    v_mul_f32 v44, 0x3fb8aa3b, v34
    v_exp_f32 v44, v44
    s_nop 0
    v_cvt_pk_bf16_f32 v44, v44, v44
    v_lshlrev_b32 v44, 16, v44
    v_mul_f32 v45, v44, v32
    v_mul_f32 v46, v44, v33
    v_mul_f32 v45, 0x3fb8aa3b, v45
    v_mul_f32 v46, 0.15915494, v46
    v_exp_f32 v45, v45
    v_rndne_f32 v47, v46
    v_sub_f32 v46, v46, v47
    v_cos_f32 v144, v46
    v_sin_f32 v145, v46
    s_nop 0
    v_mul_f32 v144, v144, v45
    v_mul_f32 v145, v145, v45
    v_mul_f32 v44, v145, v145
    v_mul_f32 v45, v144, v145
    v_fma_f32 v146, v144, v144, -v44
    v_add_f32 v147, v45, v45
    v_mul_f32 v44, v147, v147
    v_mul_f32 v45, v146, v147
    v_fma_f32 v146, v146, v146, -v44
    v_add_f32 v147, v45, v45
    v_mul_f32 v44, v147, v147
    v_mul_f32 v45, v146, v147
    v_fma_f32 v146, v146, v146, -v44
    v_add_f32 v147, v45, v45
    s_add_u32 m0, s9, 46080
    s_nop 0
    buffer_load_dwordx4 v16, s[16:19], s10 offen lds
    s_add_u32 m0, s9, 47104
    s_nop 0
    buffer_load_dwordx4 v17, s[16:19], s10 offen lds
    s_add_u32 s10, s10, 73728
    s_cmp_eq_u32 s10, 663552
    s_cselect_b32 s10, 0, s10
    v_mul_f32 v44, v147, v147
    v_mul_f32 v45, v146, v147
    v_fma_f32 v146, v146, v146, -v44
    v_add_f32 v147, v45, v45
    v_mul_f32 v44, v147, v147
    v_mul_f32 v45, v146, v147
    v_fma_f32 v148, v146, v146, -v44
    v_add_f32 v149, v45, v45
    v_mul_f32 v44, v149, v149
    v_mul_f32 v45, v148, v149
    v_fma_f32 v148, v148, v148, -v44
    v_add_f32 v149, v45, v45
    v_mul_f32 v44, v149, v149
    v_mul_f32 v45, v148, v149
    v_fma_f32 v150, v148, v148, -v44
    v_add_f32 v151, v45, v45
    v_mul_f32 v44, v151, v151
    v_mul_f32 v45, v150, v151
    v_fma_f32 v150, v150, v150, -v44
    v_add_f32 v151, v45, v45
    v_mul_f32 v44, v151, v151
    v_mul_f32 v45, v150, v151
    v_fma_f32 v150, v150, v150, -v44
    v_add_f32 v151, v45, v45
    v_lshlrev_b32 v36, 16, v36
    v_lshlrev_b32 v37, 16, v37
    v_lshlrev_b32 v38, 16, v38
    v_mul_f32 v44, 0x3fb8aa3b, v38
    v_exp_f32 v44, v44
    s_nop 0
    v_cvt_pk_bf16_f32 v44, v44, v44
    v_lshlrev_b32 v44, 16, v44
    v_mul_f32 v45, v44, v36
    s_waitcnt vmcnt(4)
    s_mov_b64 exec, 1
    ds_add_u32 v2, v3 offset:212
    s_mov_b64 exec, -1
SP_1:
    ds_read_b32 v4, v2 offset:64
    s_waitcnt lgkmcnt(0)
    v_readfirstlane_b32 s24, v4
    s_cmp_ge_u32 s24, 2
    s_cbranch_scc1 SD_2
    s_sleep 1
    s_sub_u32 s72, s72, 1
    s_cbranch_scc0 SP_1
    s_mov_b32 s72, 0
SD_2:
    s_add_u32 m0, s9, 55296
    s_nop 0
    buffer_load_dwordx4 v16, s[16:19], s10 offen lds
    s_add_u32 m0, s9, 56320
    s_nop 0
    buffer_load_dwordx4 v17, s[16:19], s10 offen lds
    s_add_u32 s10, s10, 73728
    s_cmp_eq_u32 s10, 663552
    s_cselect_b32 s10, 0, s10
    v_mul_f32 v46, v44, v37
    v_mul_f32 v45, 0x3fb8aa3b, v45
    v_mul_f32 v46, 0.15915494, v46
    v_exp_f32 v45, v45
    v_rndne_f32 v47, v46
    v_sub_f32 v46, v46, v47
    v_cos_f32 v152, v46
    v_sin_f32 v153, v46
    s_nop 0
    v_mul_f32 v152, v152, v45
    v_mul_f32 v153, v153, v45
    v_mul_f32 v44, v153, v153
    v_mul_f32 v45, v152, v153
    v_fma_f32 v154, v152, v152, -v44
    v_add_f32 v155, v45, v45
    v_mul_f32 v44, v155, v155
    v_mul_f32 v45, v154, v155
    v_fma_f32 v154, v154, v154, -v44
    v_add_f32 v155, v45, v45
    v_mul_f32 v44, v155, v155
    v_mul_f32 v45, v154, v155
    v_fma_f32 v154, v154, v154, -v44
    v_add_f32 v155, v45, v45
    v_mul_f32 v44, v155, v155
    v_mul_f32 v45, v154, v155
    v_fma_f32 v154, v154, v154, -v44
    v_add_f32 v155, v45, v45
    v_mul_f32 v44, v155, v155
    v_mul_f32 v45, v154, v155
    v_fma_f32 v156, v154, v154, -v44
    v_add_f32 v157, v45, v45
    v_mul_f32 v44, v157, v157
    s_waitcnt vmcnt(4)
    s_add_u32 m0, s9, 64512
    s_nop 0
    buffer_load_dwordx4 v16, s[16:19], s10 offen lds
    s_add_u32 m0, s9, 65536
    s_nop 0
    buffer_load_dwordx4 v17, s[16:19], s10 offen lds
    s_add_u32 s10, s10, 73728
    s_cmp_eq_u32 s10, 663552
    s_cselect_b32 s10, 0, s10
    v_mul_f32 v45, v156, v157
    v_fma_f32 v156, v156, v156, -v44
    v_add_f32 v157, v45, v45
    v_mul_f32 v44, v157, v157
    v_mul_f32 v45, v156, v157
    v_fma_f32 v158, v156, v156, -v44
    v_add_f32 v159, v45, v45
    v_mul_f32 v44, v159, v159
    v_mul_f32 v45, v158, v159
    v_fma_f32 v158, v158, v158, -v44
    v_add_f32 v159, v45, v45
    v_mul_f32 v44, v159, v159
    v_mul_f32 v45, v158, v159
    v_fma_f32 v158, v158, v158, -v44
    v_add_f32 v159, v45, v45
    v_add_f32 v52, -1.0, v152
    v_max_f32 v54, |v36|, |v37|
    v_rcp_f32 v54, v54
    s_nop 0
    v_mul_f32 v36, v36, v54
    v_mul_f32 v37, v37, v54
    v_mul_f32 v55, v36, v36
    v_fma_f32 v55, v37, v37, v55
    v_rcp_f32 v55, v55
    v_mul_f32 v48, v52, v36
    v_mul_f32 v49, v153, v36
    v_mul_f32 v55, v55, v54
    v_fma_f32 v48, v153, v37, v48
    v_fma_f32 v49, -v52, v37, v49
    v_add_f32 v55, v55, v55
    v_mul_f32 v48, v48, v55
    v_mul_f32 v49, v49, v55
    ds_write_b64 v6, v[48:49]
    s_waitcnt vmcnt(4)
    s_mov_b64 exec, 1
    ds_add_u32 v2, v3 offset:216
    s_mov_b64 exec, -1
    ds_read_b32 v4, v2 offset:192
    s_waitcnt lgkmcnt(0)
    v_readfirstlane_b32 s73, v4
    s_add_u32 m0, s9, 73728
    s_nop 0
    buffer_load_dwordx4 v16, s[16:19], s10 offen lds
    s_add_u32 m0, s9, 74752
    s_nop 0
    buffer_load_dwordx4 v17, s[16:19], s10 offen lds
    s_add_u32 s10, s10, 73728
    s_cmp_eq_u32 s10, 663552
    s_cselect_b32 s10, 0, s10
    s_setprio 3
    s_waitcnt vmcnt(2)
    s_mov_b64 exec, 1
    ds_add_u32 v2, v3 offset:220
    s_mov_b64 exec, -1
    s_waitcnt vmcnt(0)
    s_mov_b64 exec, 1
    ds_add_u32 v2, v3 offset:224
    s_mov_b64 exec, -1
    s_setprio 1
    s_branch S_REST
F_CRIT:
    s_barrier
    s_cmp_lt_u32 s6, 3
    s_cbranch_scc1 F_LO
    s_load_dword s75, s[70:71], 0
    s_setprio 3
    v_lshrrev_b32 v13, 4, v0
    v_bfe_u32 v14, v0, 2, 2
    v_lshl_add_u32 v14, v13, 3, v14
    v_mul_u32_u24 v14, 48, v14
    s_cmp_eq_u32 s6, 6
    s_cselect_b32 s7, 3, 1
    s_mov_b32 s8, 55328
    s_cselect_b32 s8, 55296, s8
    v_and_b32 v15, s7, v0
    v_lshl_add_u32 v14, v15, 3, v14
    v_add_u32 v8, s8, v14
    v_and_b32 v12, 15, v0
    v_bfe_u32 v14, v0, 1, 3
    v_xor_b32 v14, v14, v13
    v_lshlrev_b32 v14, 4, v14
    v_lshl_add_u32 v14, v12, 7, v14
    s_lshr_b32 s27, s5, 1
    s_lshl_b32 s7, s27, 11
    s_add_u32 s7, s7, 82944
    v_add_u32 v9, s7, v14
    v_xor_b32 v10, 64, v9
    v_add_u32 v11, 32768, v9
    v_add_u32 v14, 32768, v10
    s_lshl_b32 s8, s4, 1
    s_lshr_b32 s7, s27, 1
    s_add_u32 s8, s8, s7
    s_mul_i32 s8, s8, 2432
    s_add_u32 s8, s8, 524288
    s_and_b32 s27, s27, 1
    s_waitcnt vmcnt(0)
    s_mov_b64 exec, 1
    ds_add_u32 v2, v3 offset:40
    s_mov_b64 exec, -1
    s_mov_b64 exec, 1
    ds_add_u32 v2, v3 offset:208
    s_mov_b64 exec, -1
    s_waitcnt lgkmcnt(0)
    s_mul_i32 s73, s75, 0x19660d
    s_add_u32 s73, s73, 0x3c6ef35f
    v_mov_b32 v15, s73
    ds_write_b32 v2, v15 offset:192
SP_3:
    ds_read_b32 v4, v2 offset:40
    s_waitcnt lgkmcnt(0)
    v_readfirstlane_b32 s24, v4
    s_cmp_ge_u32 s24, 5
    s_cbranch_scc1 SD_4
    s_sleep 0
    s_sub_u32 s72, s72, 1
    s_cbranch_scc0 SP_3
    s_mov_b32 s72, 0
SD_4:
    s_bitcmp1_b32 s5, 0
    s_cbranch_scc1 H_V
    ds_read_b64_tr_b16 v[96:97], v8 offset:0
    ds_read_b64_tr_b16 v[98:99], v8 offset:192
    ds_read_b128 v[24:27], v9 offset:0
    ds_read_b64_tr_b16 v[100:101], v8 offset:1536
    ds_read_b64_tr_b16 v[102:103], v8 offset:1728
    ds_read_b128 v[28:31], v10 offset:0
    ds_read_b64_tr_b16 v[104:105], v8 offset:3072
    ds_read_b64_tr_b16 v[106:107], v8 offset:3264
    ds_read_b128 v[32:35], v9 offset:8192
    ds_read_b64_tr_b16 v[108:109], v8 offset:4608
    ds_read_b64_tr_b16 v[110:111], v8 offset:4800
    ds_read_b128 v[36:39], v10 offset:8192
    ds_read_b64_tr_b16 v[112:113], v8 offset:6144
    ds_read_b64_tr_b16 v[114:115], v8 offset:6336
    ds_read_b128 v[40:43], v9 offset:16384
    s_waitcnt lgkmcnt(12)
    v_mfma_f32_16x16x32_bf16 v[16:19], v[96:99], v[24:27], 0
    ds_read_b64_tr_b16 v[116:117], v8 offset:7680
    ds_read_b64_tr_b16 v[118:119], v8 offset:7872
    ds_read_b128 v[44:47], v10 offset:16384
    s_waitcnt lgkmcnt(12)
    v_mfma_f32_16x16x32_bf16 v[16:19], v[100:103], v[28:31], v[16:19]
    ds_read_b64_tr_b16 v[120:121], v8 offset:9216
    ds_read_b64_tr_b16 v[122:123], v8 offset:9408
    ds_read_b128 v[48:51], v9 offset:24576
    s_waitcnt lgkmcnt(12)
    v_mfma_f32_16x16x32_bf16 v[16:19], v[104:107], v[32:35], v[16:19]
    ds_read_b64_tr_b16 v[124:125], v8 offset:10752
    ds_read_b64_tr_b16 v[126:127], v8 offset:10944
    ds_read_b128 v[52:55], v10 offset:24576
    s_waitcnt lgkmcnt(12)
    v_mfma_f32_16x16x32_bf16 v[16:19], v[108:111], v[36:39], v[16:19]
    ds_read_b64_tr_b16 v[128:129], v8 offset:12288
    ds_read_b64_tr_b16 v[130:131], v8 offset:12480
    ds_read_b128 v[56:59], v11 offset:0
    s_waitcnt lgkmcnt(12)
    v_mfma_f32_16x16x32_bf16 v[16:19], v[112:115], v[40:43], v[16:19]
    ds_read_b64_tr_b16 v[132:133], v8 offset:13824
    ds_read_b64_tr_b16 v[134:135], v8 offset:14016
    ds_read_b128 v[60:63], v14 offset:0
    s_waitcnt lgkmcnt(12)
    v_mfma_f32_16x16x32_bf16 v[16:19], v[116:119], v[44:47], v[16:19]
    ds_read_b64_tr_b16 v[136:137], v8 offset:15360
    ds_read_b64_tr_b16 v[138:139], v8 offset:15552
    ds_read_b128 v[64:67], v11 offset:8192
    s_waitcnt lgkmcnt(12)
    v_mfma_f32_16x16x32_bf16 v[16:19], v[120:123], v[48:51], v[16:19]
    ds_read_b64_tr_b16 v[140:141], v8 offset:16896
    ds_read_b64_tr_b16 v[142:143], v8 offset:17088
    ds_read_b128 v[68:71], v14 offset:8192
    s_waitcnt lgkmcnt(12)
    v_mfma_f32_16x16x32_bf16 v[16:19], v[124:127], v[52:55], v[16:19]
    ds_read_b64_tr_b16 v[144:145], v8 offset:18432
    ds_read_b64_tr_b16 v[146:147], v8 offset:18624
    ds_read_b128 v[72:75], v11 offset:16384
    s_waitcnt lgkmcnt(12)
    v_mfma_f32_16x16x32_bf16 v[16:19], v[128:131], v[56:59], v[16:19]
    ds_read_b64_tr_b16 v[148:149], v8 offset:19968
    ds_read_b64_tr_b16 v[150:151], v8 offset:20160
    ds_read_b128 v[76:79], v14 offset:16384
    s_waitcnt lgkmcnt(12)
    v_mfma_f32_16x16x32_bf16 v[16:19], v[132:135], v[60:63], v[16:19]
    ds_read_b64_tr_b16 v[152:153], v8 offset:21504
    ds_read_b64_tr_b16 v[154:155], v8 offset:21696
    ds_read_b128 v[80:83], v11 offset:24576
    s_waitcnt lgkmcnt(12)
    v_mfma_f32_16x16x32_bf16 v[16:19], v[136:139], v[64:67], v[16:19]
    ds_read_b64_tr_b16 v[156:157], v8 offset:23040
    ds_read_b64_tr_b16 v[158:159], v8 offset:23232
    ds_read_b128 v[84:87], v14 offset:24576
    s_waitcnt lgkmcnt(12)
    v_mfma_f32_16x16x32_bf16 v[16:19], v[140:143], v[68:71], v[16:19]
    ds_read_b64_tr_b16 v[160:161], v8 offset:24576
    ds_read_b64_tr_b16 v[162:163], v8 offset:24768
    ds_read_b128 v[88:91], v11 offset:32768
    s_waitcnt lgkmcnt(12)
    v_mfma_f32_16x16x32_bf16 v[16:19], v[144:147], v[72:75], v[16:19]
    ds_read_b64_tr_b16 v[164:165], v8 offset:26112
    ds_read_b64_tr_b16 v[166:167], v8 offset:26304
    ds_read_b128 v[92:95], v14 offset:32768
    s_waitcnt lgkmcnt(12)
    v_mfma_f32_16x16x32_bf16 v[16:19], v[148:151], v[76:79], v[16:19]
    s_waitcnt lgkmcnt(9)
    v_mfma_f32_16x16x32_bf16 v[16:19], v[152:155], v[80:83], v[16:19]
    s_waitcnt lgkmcnt(6)
    v_mfma_f32_16x16x32_bf16 v[16:19], v[156:159], v[84:87], v[16:19]
    s_waitcnt lgkmcnt(3)
    v_mfma_f32_16x16x32_bf16 v[16:19], v[160:163], v[88:91], v[16:19]
    s_waitcnt lgkmcnt(0)
    v_mfma_f32_16x16x32_bf16 v[16:19], v[164:167], v[92:95], v[16:19]
    s_mov_b64 exec, 1
    ds_add_u32 v2, v3 offset:64
    s_mov_b64 exec, -1
    s_lshl_b32 s7, s27, 4
    v_add_u32 v12, s7, v12
    v_lshrrev_b32 v14, 1, v13
    v_and_b32 v15, 1, v13
    s_nop 1
    v_cvt_pk_bf16_f32 v20, v16, v17
    v_cvt_pk_bf16_f32 v21, v18, v19
    s_cmp_eq_u32 s6, 7
    s_cbranch_scc1 H_KX
    v_lshl_add_u32 v12, v14, 5, v12
    v_lshlrev_b32 v12, 4, v12
    v_lshl_add_u32 v12, v15, 3, v12
    buffer_store_dwordx2 v[20:21], v12, s[32:35], s8 offen sc1
    s_branch H_KVD
H_KX:
    v_lshlrev_b32 v12, 2, v12
    s_mov_b32 exec_lo, 0xffff0000
    s_mov_b32 exec_hi, 0
    buffer_store_dword v21, v12, s[32:35], s8 offen offset:1024 sc1
    s_branch H_KVD
H_V:
    ds_read_b64_tr_b16 v[96:97], v8 offset:0
    ds_read_b64_tr_b16 v[98:99], v8 offset:192
    ds_read_b128 v[24:27], v9 offset:0
    ds_read_b64_tr_b16 v[100:101], v8 offset:1536
    ds_read_b64_tr_b16 v[102:103], v8 offset:1728
    ds_read_b128 v[28:31], v10 offset:0
    ds_read_b64_tr_b16 v[104:105], v8 offset:3072
    ds_read_b64_tr_b16 v[106:107], v8 offset:3264
    ds_read_b128 v[32:35], v9 offset:8192
    ds_read_b64_tr_b16 v[108:109], v8 offset:4608
    ds_read_b64_tr_b16 v[110:111], v8 offset:4800
    ds_read_b128 v[36:39], v10 offset:8192
    ds_read_b64_tr_b16 v[112:113], v8 offset:6144
    ds_read_b64_tr_b16 v[114:115], v8 offset:6336
    ds_read_b128 v[40:43], v9 offset:16384
    s_waitcnt lgkmcnt(12)
    v_mfma_f32_16x16x32_bf16 v[16:19], v[24:27], v[96:99], 0
    ds_read_b64_tr_b16 v[116:117], v8 offset:7680
    ds_read_b64_tr_b16 v[118:119], v8 offset:7872
    ds_read_b128 v[44:47], v10 offset:16384
    s_waitcnt lgkmcnt(12)
    v_mfma_f32_16x16x32_bf16 v[16:19], v[28:31], v[100:103], v[16:19]
    ds_read_b64_tr_b16 v[120:121], v8 offset:9216
    ds_read_b64_tr_b16 v[122:123], v8 offset:9408
    ds_read_b128 v[48:51], v9 offset:24576
    s_waitcnt lgkmcnt(12)
    v_mfma_f32_16x16x32_bf16 v[16:19], v[32:35], v[104:107], v[16:19]
    ds_read_b64_tr_b16 v[124:125], v8 offset:10752
    ds_read_b64_tr_b16 v[126:127], v8 offset:10944
    ds_read_b128 v[52:55], v10 offset:24576
    s_waitcnt lgkmcnt(12)
    v_mfma_f32_16x16x32_bf16 v[16:19], v[36:39], v[108:111], v[16:19]
    ds_read_b64_tr_b16 v[128:129], v8 offset:12288
    ds_read_b64_tr_b16 v[130:131], v8 offset:12480
    ds_read_b128 v[56:59], v11 offset:0
    s_waitcnt lgkmcnt(12)
    v_mfma_f32_16x16x32_bf16 v[16:19], v[40:43], v[112:115], v[16:19]
    ds_read_b64_tr_b16 v[132:133], v8 offset:13824
    ds_read_b64_tr_b16 v[134:135], v8 offset:14016
    ds_read_b128 v[60:63], v14 offset:0
    s_waitcnt lgkmcnt(12)
    v_mfma_f32_16x16x32_bf16 v[16:19], v[44:47], v[116:119], v[16:19]
    ds_read_b64_tr_b16 v[136:137], v8 offset:15360
    ds_read_b64_tr_b16 v[138:139], v8 offset:15552
    ds_read_b128 v[64:67], v11 offset:8192
    s_waitcnt lgkmcnt(12)
    v_mfma_f32_16x16x32_bf16 v[16:19], v[48:51], v[120:123], v[16:19]
    ds_read_b64_tr_b16 v[140:141], v8 offset:16896
    ds_read_b64_tr_b16 v[142:143], v8 offset:17088
    ds_read_b128 v[68:71], v14 offset:8192
    s_waitcnt lgkmcnt(12)
    v_mfma_f32_16x16x32_bf16 v[16:19], v[52:55], v[124:127], v[16:19]
    ds_read_b64_tr_b16 v[144:145], v8 offset:18432
    ds_read_b64_tr_b16 v[146:147], v8 offset:18624
    ds_read_b128 v[72:75], v11 offset:16384
    s_waitcnt lgkmcnt(12)
    v_mfma_f32_16x16x32_bf16 v[16:19], v[56:59], v[128:131], v[16:19]
    ds_read_b64_tr_b16 v[148:149], v8 offset:19968
    ds_read_b64_tr_b16 v[150:151], v8 offset:20160
    ds_read_b128 v[76:79], v14 offset:16384
    s_waitcnt lgkmcnt(12)
    v_mfma_f32_16x16x32_bf16 v[16:19], v[60:63], v[132:135], v[16:19]
    ds_read_b64_tr_b16 v[152:153], v8 offset:21504
    ds_read_b64_tr_b16 v[154:155], v8 offset:21696
    ds_read_b128 v[80:83], v11 offset:24576
    s_waitcnt lgkmcnt(12)
    v_mfma_f32_16x16x32_bf16 v[16:19], v[64:67], v[136:139], v[16:19]
    ds_read_b64_tr_b16 v[156:157], v8 offset:23040
    ds_read_b64_tr_b16 v[158:159], v8 offset:23232
    ds_read_b128 v[84:87], v14 offset:24576
    s_waitcnt lgkmcnt(12)
    v_mfma_f32_16x16x32_bf16 v[16:19], v[68:71], v[140:143], v[16:19]
    ds_read_b64_tr_b16 v[160:161], v8 offset:24576
    ds_read_b64_tr_b16 v[162:163], v8 offset:24768
    ds_read_b128 v[88:91], v11 offset:32768
    s_waitcnt lgkmcnt(12)
    v_mfma_f32_16x16x32_bf16 v[16:19], v[72:75], v[144:147], v[16:19]
    ds_read_b64_tr_b16 v[164:165], v8 offset:26112
    ds_read_b64_tr_b16 v[166:167], v8 offset:26304
    ds_read_b128 v[92:95], v14 offset:32768
    s_waitcnt lgkmcnt(12)
    v_mfma_f32_16x16x32_bf16 v[16:19], v[76:79], v[148:151], v[16:19]
    s_waitcnt lgkmcnt(9)
    v_mfma_f32_16x16x32_bf16 v[16:19], v[80:83], v[152:155], v[16:19]
    s_waitcnt lgkmcnt(6)
    v_mfma_f32_16x16x32_bf16 v[16:19], v[84:87], v[156:159], v[16:19]
    s_waitcnt lgkmcnt(3)
    v_mfma_f32_16x16x32_bf16 v[16:19], v[88:91], v[160:163], v[16:19]
    s_waitcnt lgkmcnt(0)
    v_mfma_f32_16x16x32_bf16 v[16:19], v[92:95], v[164:167], v[16:19]
    s_mov_b64 exec, 1
    ds_add_u32 v2, v3 offset:64
    s_mov_b64 exec, -1
    s_mul_i32 s7, s27, 640
    s_add_u32 s8, s8, s7
    v_lshrrev_b32 v15, 1, v13
    v_mul_u32_u24 v15, 18, v15
    v_add_u32 v12, v12, v15
    v_cvt_pk_bf16_f32 v20, v16, v17
    v_cvt_pk_bf16_f32 v21, v18, v19
    v_lshlrev_b32 v12, 4, v12
    v_and_b32 v14, 1, v13
    v_lshl_add_u32 v12, v14, 3, v12
    s_cmp_eq_u32 s6, 7
    s_cbranch_scc1 H_VX
    buffer_store_dwordx2 v[20:21], v12, s[32:35], s8 offen offset:1152 sc1
    s_branch H_KVD
H_VX:
    s_mov_b32 exec_lo, 0x00c000c0
    s_mov_b32 exec_hi, 0x00c000c0
    buffer_store_dwordx2 v[20:21], v12, s[32:35], s8 offen offset:1312 sc1
    s_mov_b64 exec, 0xffff
    v_mov_b32 v22, 0
    v_lshlrev_b32 v12, 2, v0
    s_mov_b64 exec, 0xf
    v_mov_b32 v22, 0x3f803f80
    s_mov_b64 exec, 0xffff
    buffer_store_dword v22, v12, s[32:35], s8 offen offset:1728 sc1
H_KVD:
    s_mov_b64 exec, -1
    s_lshr_b32 s10, s6, 2
    s_mul_i32 s11, s10, 2432
    v_add_u32 v146, s11, v1
    v_and_b32 v6, 31, v0
    v_lshrrev_b32 v7, 5, v0
    s_add_u32 s7, s11, 1024
    v_lshl_add_u32 v147, v6, 2, s7
    v_mul_u32_u24 v5, 18, v7
    v_add_u32 v5, v5, v6
    s_mov_b32 exec_lo, 0xfffc0000
    s_mov_b32 exec_hi, 0xfffc0000
    v_mov_b32 v5, 37
    s_mov_b32 exec_lo, 0x00440000
    s_mov_b32 exec_hi, 0x00440000
    v_mov_b32 v5, 36
    s_mov_b64 exec, -1
    v_lshlrev_b32 v151, 4, v5
    v_add_u32 v148, s11, v151
    v_mov_b32 v150, v2
    v_bfe_u32 v5, v0, 2, 1
    v_lshlrev_b32 v5, 4, v5
    v_bfe_u32 v7, v0, 3, 2
    v_lshl_add_u32 v5, v7, 2, v5
    v_and_b32 v7, 3, v0
    v_add_u32 v5, v5, v7
    s_and_b32 s7, s6, 1
    s_lshl_b32 s7, s7, 7
    s_add_u32 s7, s7, 161536
    v_lshl_add_u32 v152, v5, 2, s7
    v_mov_b32 v88, 0
    v_mov_b32 v89, 0
    v_mov_b32 v90, 0
    v_mov_b32 v91, 0
    v_mov_b32 v92, 0
    v_mov_b32 v93, 0
    v_mov_b32 v94, 0
    v_mov_b32 v95, 0
    v_mov_b32 v96, 0
    v_mov_b32 v97, 0
    v_mov_b32 v98, 0
    v_mov_b32 v99, 0
    v_mov_b32 v100, 0
    v_mov_b32 v101, 0
    v_mov_b32 v102, 0
    v_mov_b32 v103, 0
    v_mov_b32 v104, 0
    v_mov_b32 v105, 0
    v_mov_b32 v106, 0
    v_mov_b32 v107, 0
    v_mov_b32 v108, 0
    v_mov_b32 v109, 0
    v_mov_b32 v110, 0
    v_mov_b32 v111, 0
    v_mov_b32 v112, 0
    v_mov_b32 v113, 0
    v_mov_b32 v114, 0
    v_mov_b32 v115, 0
    v_mov_b32 v116, 0
    v_mov_b32 v117, 0
    v_mov_b32 v118, 0
    v_mov_b32 v119, 0
    v_mov_b32 v132, 0
    v_mov_b32 v133, 0
    v_mov_b32 v134, 0
    v_mov_b32 v135, 0
    v_mov_b32 v125, 0
    v_mov_b32 v153, 0xdddd
    s_cmp_eq_u32 s10, 0
    s_cselect_b32 s7, 0x101, 1
    v_mov_b32 v157, s7
    s_xor_b32 s7, s6, 0
    s_mul_i32 s12, s7, 3072
    s_add_u32 s12, s12, 115712
    s_cmp_eq_u32 s7, 6
    s_cselect_b32 s12, 94208, s12
    s_cmp_eq_u32 s7, 7
    s_cselect_b32 s12, 156928, s12
    s_xor_b32 s7, s6, 4
    s_mul_i32 s13, s7, 3072
    s_add_u32 s13, s13, 115712
    s_cmp_eq_u32 s7, 6
    s_cselect_b32 s13, 94208, s13
    s_cmp_eq_u32 s7, 7
    s_cselect_b32 s13, 156928, s13
    v_add_u32 v80, s12, v1
    v_add_u32 v81, s13, v1
    s_lshl_b32 s7, s6, 2
    v_add_u32 v82, s7, v2
    v_xor_b32 v83, 16, v82
    s_and_b32 s7, s6, 1
    s_lshl_b32 s8, s4, 1
    s_add_u32 s7, s7, s8
    s_lshl_b32 s7, s7, 5
    s_and_b32 s8, s6, 2
    s_add_u32 s7, s7, s8
    s_add_u32 s7, s7, s10
    s_lshl_b32 s8, s5, 2
    s_add_u32 s7, s7, s8
    s_lshl_b32 s15, s7, 7
    s_add_u32 s15, s15, 65536
    s_lshl_b32 s14, s7, 10
    s_add_u32 s14, s14, 9437184
    s_and_b32 s8, s6, 3
    s_mul_i32 s8, s8, 2560
    v_add_u32 v158, s8, v1
    v_lshl_add_u32 v159, v0, 3, s8
    s_lshr_b32 s8, s2, 2
    s_lshl_b32 s8, s8, 7
    s_and_b32 s24, s2, 3
    s_lshl_b32 s24, s24, 2
    s_add_u32 s8, s8, s24
    s_add_u32 s8, s8, 4653056
    s_waitcnt vmcnt(0)
    s_mov_b64 exec, 1
    ds_add_rtn_u32 v4, v2, v3 offset:96
    s_waitcnt lgkmcnt(0)
    v_readfirstlane_b32 s24, v4
    s_mov_b64 exec, -1
    s_cmp_lg_u32 s24, 1
    s_cbranch_scc1 LF_5
    v_lshlrev_b32 v4, 13, v0
    v_mov_b32 v5, s73
    s_mov_b64 exec, 255
    buffer_store_dword v5, v4, s[32:35], s8 offen sc1
    s_mov_b64 exec, -1
LF_5:
    s_cmp_eq_u32 s6, 7
    s_cbranch_scc1 H_NOPOLL
SP_6:
    ds_read_b32 v4, v2 offset:216
    s_waitcnt lgkmcnt(0)
    v_readfirstlane_b32 s24, v4
    s_cmp_ge_u32 s24, 4
    s_cbranch_scc1 SD_7
    s_sleep 2
    s_sub_u32 s72, s72, 1
    s_cbranch_scc0 SP_6
    s_mov_b32 s72, 0
SD_7:
    s_and_b32 s7, s2, 7
    s_lshl_b32 s7, s7, 13
    s_add_u32 s7, s7, 4653056
    v_lshlrev_b32 v12, 7, v0
PL_8:
    buffer_load_dwordx4 v[8:11], v12, s[32:35], s7 offen sc1
    s_waitcnt vmcnt(0)
    v_xor_b32 v4, s73, v8
    v_bitop3_b32 v4, v4, v9, s73 bitop3:0xf6
    v_bitop3_b32 v4, v4, v10, s73 bitop3:0xf6
    v_bitop3_b32 v4, v4, v11, s73 bitop3:0xf6
    v_cmp_ne_u32 vcc, 0, v4
    s_cbranch_vccz PD_9
    s_mov_b64 exec, vcc
    s_sleep 4
    s_sub_u32 s72, s72, 1
    s_cbranch_scc0 PL_8
    s_mov_b32 s72, 0
PD_9:
    s_mov_b64 exec, 1
    ds_add_u32 v2, v3 offset:92
    s_mov_b64 exec, -1
    s_cmp_lg_u32 s2, 0
    s_cbranch_scc1 H_NOPOLL
    s_mov_b32 s7, 0
    v_lshlrev_b32 v4, 13, v0
    v_mov_b32 v5, s73
    s_mov_b64 exec, 1
    buffer_store_dword v5, v4, s[32:35], s7 offen sc1
    s_mov_b64 exec, -1
H_NOPOLL:
SP_10:
    ds_read_b32 v4, v2 offset:92
    s_waitcnt lgkmcnt(0)
    v_readfirstlane_b32 s24, v4
    s_cmp_ge_u32 s24, 1
    s_cbranch_scc1 SD_11
    s_sleep 1
    s_sub_u32 s72, s72, 1
    s_cbranch_scc0 SP_10
    s_mov_b32 s72, 0
SD_11:
SP_12:
    ds_read_b32 v4, v2 offset:44
    s_waitcnt lgkmcnt(0)
    v_readfirstlane_b32 s24, v4
    s_cmp_ge_u32 s24, 6
    s_cbranch_scc1 SD_13
    s_sleep 1
    s_sub_u32 s72, s72, 1
    s_cbranch_scc0 SP_12
    s_mov_b32 s72, 0
SD_13:
    s_and_b32 s7, s6, 1
    s_lshl_b32 s7, s7, 10
    s_add_u32 s8, s7, 524288
    s_add_u32 m0, s7, 0
    s_add_u32 s9, s8, 0
    buffer_load_dwordx4 v1, s[32:35], s9 offen offset:0 sc1 lds
    buffer_load_dwordx4 v1, s[32:35], s9 offen offset:2048 sc1 lds
    s_add_u32 m0, s7, 4096
    s_add_u32 s9, s8, 4096
    buffer_load_dwordx4 v1, s[32:35], s9 offen offset:0 sc1 lds
    buffer_load_dwordx4 v1, s[32:35], s9 offen offset:2048 sc1 lds
    s_add_u32 m0, s7, 8192
    s_add_u32 s9, s8, 8192
    buffer_load_dwordx4 v1, s[32:35], s9 offen offset:0 sc1 lds
    buffer_load_dwordx4 v1, s[32:35], s9 offen offset:2048 sc1 lds
    s_add_u32 m0, s7, 12288
    s_add_u32 s9, s8, 12288
    buffer_load_dwordx4 v1, s[32:35], s9 offen offset:0 sc1 lds
    buffer_load_dwordx4 v1, s[32:35], s9 offen offset:2048 sc1 lds
    s_add_u32 m0, s7, 16384
    s_add_u32 s9, s8, 16384
    buffer_load_dwordx4 v1, s[32:35], s9 offen offset:0 sc1 lds
    buffer_load_dwordx4 v1, s[32:35], s9 offen offset:2048 sc1 lds
    s_mov_b64 exec, 1
    ds_add_u32 v2, v3 offset:116
    s_mov_b64 exec, -1
SP_14:
    ds_read_b32 v4, v2 offset:68
    s_waitcnt lgkmcnt(0)
    v_readfirstlane_b32 s24, v4
    s_cmp_ge_u32 s24, 6
    s_cbranch_scc1 SD_15
    s_sleep 1
    s_sub_u32 s72, s72, 1
    s_cbranch_scc0 SP_14
    s_mov_b32 s72, 0
SD_15:
    s_add_u32 m0, s7, 20480
    s_add_u32 s9, s8, 20480
    buffer_load_dwordx4 v1, s[32:35], s9 offen offset:0 sc1 lds
    buffer_load_dwordx4 v1, s[32:35], s9 offen offset:2048 sc1 lds
    s_add_u32 m0, s7, 24576
    s_add_u32 s9, s8, 24576
    buffer_load_dwordx4 v1, s[32:35], s9 offen offset:0 sc1 lds
    buffer_load_dwordx4 v1, s[32:35], s9 offen offset:2048 sc1 lds
    s_add_u32 m0, s7, 28672
    s_add_u32 s9, s8, 28672
    buffer_load_dwordx4 v1, s[32:35], s9 offen offset:0 sc1 lds
    buffer_load_dwordx4 v1, s[32:35], s9 offen offset:2048 sc1 lds
    s_add_u32 m0, s7, 32768
    s_add_u32 s9, s8, 32768
    buffer_load_dwordx4 v1, s[32:35], s9 offen offset:0 sc1 lds
    buffer_load_dwordx4 v1, s[32:35], s9 offen offset:2048 sc1 lds
    s_add_u32 m0, s7, 36864
    s_add_u32 s9, s8, 36864
    buffer_load_dwordx4 v1, s[32:35], s9 offen offset:0 sc1 lds
    buffer_load_dwordx4 v1, s[32:35], s9 offen offset:2048 sc1 lds
    s_waitcnt vmcnt(10)
    s_mov_b64 exec, 1
    ds_add_u32 v2, v3 offset:204
    s_mov_b64 exec, -1
    s_setprio 0
    s_branch A_JOIN
F_LO:
    s_waitcnt vmcnt(0)
    s_mov_b64 exec, 1
    ds_add_u32 v2, v3 offset:40
    s_mov_b64 exec, -1
    s_setprio 2
    s_cmp_eq_u32 s6, 0
    s_cbranch_scc1 H_R8
    s_branch H_PDONE
H_R8:
    s_mov_b32 s16, s56
    s_mov_b32 s17, s57
    s_mov_b32 s18, 663552
    s_mov_b32 s19, 0x20000
    s_mul_i32 s25, s5, 144
    v_add_u32 v22, 512, v0
    v_mul_u32_u24 v23, 7282, v22
    v_lshrrev_b32 v23, 16, v23
    v_mul_u32_u24 v24, 9, v23
    v_sub_u32 v24, v22, v24
    v_and_b32 v25, 48, v23
    v_and_b32 v26, 3, v23
    v_lshl_or_b32 v25, v26, 2, v25
    v_bfe_u32 v26, v23, 2, 2
    v_or_b32 v25, v25, v26
    v_mul_u32_u24 v25, 1152, v25
    v_lshl_add_u32 v25, v24, 4, v25
    v_add_u32 v18, s25, v25
    s_mul_i32 s30, s74, 73728
    s_mov_b32 m0, 8192
    s_nop 0
    buffer_load_dwordx4 v18, s[16:19], s30 offen lds
    s_add_u32 s30, s30, 73728
    s_cmp_eq_u32 s30, 663552
    s_cselect_b32 s30, 0, s30
    s_mov_b32 m0, 17408
    s_nop 0
    buffer_load_dwordx4 v18, s[16:19], s30 offen lds
    s_add_u32 s30, s30, 73728
    s_cmp_eq_u32 s30, 663552
    s_cselect_b32 s30, 0, s30
    s_mov_b32 m0, 26624
    s_nop 0
    buffer_load_dwordx4 v18, s[16:19], s30 offen lds
    s_add_u32 s30, s30, 73728
    s_cmp_eq_u32 s30, 663552
    s_cselect_b32 s30, 0, s30
    s_mov_b32 m0, 35840
    s_nop 0
    buffer_load_dwordx4 v18, s[16:19], s30 offen lds
    s_add_u32 s30, s30, 73728
    s_cmp_eq_u32 s30, 663552
    s_cselect_b32 s30, 0, s30
    s_mov_b32 m0, 45056
    s_nop 0
    buffer_load_dwordx4 v18, s[16:19], s30 offen lds
    s_add_u32 s30, s30, 73728
    s_cmp_eq_u32 s30, 663552
    s_cselect_b32 s30, 0, s30
    s_mov_b32 m0, 54272
    s_nop 0
    buffer_load_dwordx4 v18, s[16:19], s30 offen lds
    s_add_u32 s30, s30, 73728
    s_cmp_eq_u32 s30, 663552
    s_cselect_b32 s30, 0, s30
SP_16:
    ds_read_b32 v4, v2 offset:64
    s_waitcnt lgkmcnt(0)
    v_readfirstlane_b32 s24, v4
    s_cmp_ge_u32 s24, 2
    s_cbranch_scc1 SD_17
    s_sleep 1
    s_sub_u32 s72, s72, 1
    s_cbranch_scc0 SP_16
    s_mov_b32 s72, 0
SD_17:
    s_mov_b32 m0, 63488
    s_nop 0
    buffer_load_dwordx4 v18, s[16:19], s30 offen lds
    s_add_u32 s30, s30, 73728
    s_cmp_eq_u32 s30, 663552
    s_cselect_b32 s30, 0, s30
    s_mov_b32 m0, 72704
    s_nop 0
    buffer_load_dwordx4 v18, s[16:19], s30 offen lds
    s_add_u32 s30, s30, 73728
    s_cmp_eq_u32 s30, 663552
    s_cselect_b32 s30, 0, s30
    s_mov_b32 m0, 81920
    s_nop 0
    buffer_load_dwordx4 v18, s[16:19], s30 offen lds
    s_add_u32 s30, s30, 73728
    s_cmp_eq_u32 s30, 663552
    s_cselect_b32 s30, 0, s30
    s_waitcnt vmcnt(0)
    s_mov_b64 exec, 1
    ds_add_u32 v2, v3 offset:208
    s_mov_b64 exec, -1
    s_branch H_PDONE
F_GATE:
    s_mov_b32 s32, s70
    s_mov_b32 s33, s71
    s_mov_b32 s34, 12582912
    s_mov_b32 s35, 0x20000
    s_mov_b32 s16, s64
    s_mov_b32 s17, s65
    s_mov_b32 s18, 1152
    s_mov_b32 s19, 0x20000
    buffer_load_dwordx4 v[100:103], v7, s[16:19], s10 offen
    s_add_u32 s10, s10, 128
    s_cmp_eq_u32 s10, 1152
    s_cselect_b32 s10, 0, s10
    buffer_load_dwordx4 v[104:107], v7, s[16:19], s10 offen
    s_add_u32 s10, s10, 128
    s_cmp_eq_u32 s10, 1152
    s_cselect_b32 s10, 0, s10
    buffer_load_dwordx4 v[108:111], v7, s[16:19], s10 offen
    s_add_u32 s10, s10, 128
    s_cmp_eq_u32 s10, 1152
    s_cselect_b32 s10, 0, s10
    buffer_load_dwordx4 v[112:115], v7, s[16:19], s10 offen
    s_add_u32 s10, s10, 128
    s_cmp_eq_u32 s10, 1152
    s_cselect_b32 s10, 0, s10
    buffer_load_dwordx4 v[116:119], v7, s[16:19], s10 offen
    s_add_u32 s10, s10, 128
    s_cmp_eq_u32 s10, 1152
    s_cselect_b32 s10, 0, s10
    buffer_load_dwordx4 v[120:123], v7, s[16:19], s10 offen
    s_add_u32 s10, s10, 128
    s_cmp_eq_u32 s10, 1152
    s_cselect_b32 s10, 0, s10
    buffer_load_dwordx4 v[124:127], v7, s[16:19], s10 offen
    s_add_u32 s10, s10, 128
    s_cmp_eq_u32 s10, 1152
    s_cselect_b32 s10, 0, s10
    buffer_load_dwordx4 v[128:131], v7, s[16:19], s10 offen
    s_add_u32 s10, s10, 128
    s_cmp_eq_u32 s10, 1152
    s_cselect_b32 s10, 0, s10
    buffer_load_dwordx4 v[132:135], v7, s[16:19], s10 offen
    s_add_u32 s10, s10, 128
    s_cmp_eq_u32 s10, 1152
    s_cselect_b32 s10, 0, s10
    v_add_u32 v14, s9, v1
    v_add_u32 v15, 32768, v14
SP_18:
    ds_read_b32 v4, v2 offset:40
    s_waitcnt lgkmcnt(0)
    v_readfirstlane_b32 s24, v4
    s_cmp_ge_u32 s24, 5
    s_cbranch_scc1 SD_19
    s_sleep 1
    s_sub_u32 s72, s72, 1
    s_cbranch_scc0 SP_18
    s_mov_b32 s72, 0
SD_19:
    ds_read_b128 v[64:67], v14 offset:0
    ds_read_b128 v[68:71], v14 offset:8192
    ds_read_b128 v[72:75], v14 offset:16384
    ds_read_b128 v[76:79], v14 offset:24576
    ds_read_b128 v[80:83], v15 offset:0
    ds_read_b128 v[84:87], v15 offset:8192
    ds_read_b128 v[88:91], v15 offset:16384
    ds_read_b128 v[92:95], v15 offset:24576
    ds_read_b128 v[96:99], v15 offset:32768
    v_mov_b32 v16, 0
    v_mov_b32 v17, 0
    s_waitcnt vmcnt(0) lgkmcnt(0)
    v_lshlrev_b32 v18, 16, v64
    v_and_b32 v19, 0xffff0000, v64
    v_lshlrev_b32 v20, 16, v100
    v_and_b32 v21, 0xffff0000, v100
    v_mul_f32 v18, v18, v20
    v_mul_f32 v19, v19, v21
    v_cvt_pk_bf16_f32 v18, v18, v19
    v_and_b32 v19, 0xffff0000, v18
    v_lshlrev_b32 v18, 16, v18
    v_add_f32 v17, v17, v19
    v_add_f32 v16, v16, v18
    v_lshlrev_b32 v18, 16, v65
    v_and_b32 v19, 0xffff0000, v65
    v_lshlrev_b32 v20, 16, v101
    v_and_b32 v21, 0xffff0000, v101
    v_mul_f32 v18, v18, v20
    v_mul_f32 v19, v19, v21
    v_cvt_pk_bf16_f32 v18, v18, v19
    v_and_b32 v19, 0xffff0000, v18
    v_lshlrev_b32 v18, 16, v18
    v_add_f32 v17, v17, v19
    v_add_f32 v16, v16, v18
    v_lshlrev_b32 v18, 16, v66
    v_and_b32 v19, 0xffff0000, v66
    v_lshlrev_b32 v20, 16, v102
    v_and_b32 v21, 0xffff0000, v102
    v_mul_f32 v18, v18, v20
    v_mul_f32 v19, v19, v21
    v_cvt_pk_bf16_f32 v18, v18, v19
    v_and_b32 v19, 0xffff0000, v18
    v_lshlrev_b32 v18, 16, v18
    v_add_f32 v17, v17, v19
    v_add_f32 v16, v16, v18
    v_lshlrev_b32 v18, 16, v67
    v_and_b32 v19, 0xffff0000, v67
    v_lshlrev_b32 v20, 16, v103
    v_and_b32 v21, 0xffff0000, v103
    v_mul_f32 v18, v18, v20
    v_mul_f32 v19, v19, v21
    v_cvt_pk_bf16_f32 v18, v18, v19
    v_and_b32 v19, 0xffff0000, v18
    v_lshlrev_b32 v18, 16, v18
    v_add_f32 v17, v17, v19
    v_add_f32 v16, v16, v18
    v_lshlrev_b32 v18, 16, v68
    v_and_b32 v19, 0xffff0000, v68
    v_lshlrev_b32 v20, 16, v104
    v_and_b32 v21, 0xffff0000, v104
    v_mul_f32 v18, v18, v20
    v_mul_f32 v19, v19, v21
    v_cvt_pk_bf16_f32 v18, v18, v19
    v_and_b32 v19, 0xffff0000, v18
    v_lshlrev_b32 v18, 16, v18
    v_add_f32 v17, v17, v19
    v_add_f32 v16, v16, v18
    v_lshlrev_b32 v18, 16, v69
    v_and_b32 v19, 0xffff0000, v69
    v_lshlrev_b32 v20, 16, v105
    v_and_b32 v21, 0xffff0000, v105
    v_mul_f32 v18, v18, v20
    v_mul_f32 v19, v19, v21
    v_cvt_pk_bf16_f32 v18, v18, v19
    v_and_b32 v19, 0xffff0000, v18
    v_lshlrev_b32 v18, 16, v18
    v_add_f32 v17, v17, v19
    v_add_f32 v16, v16, v18
    v_lshlrev_b32 v18, 16, v70
    v_and_b32 v19, 0xffff0000, v70
    v_lshlrev_b32 v20, 16, v106
    v_and_b32 v21, 0xffff0000, v106
    v_mul_f32 v18, v18, v20
    v_mul_f32 v19, v19, v21
    v_cvt_pk_bf16_f32 v18, v18, v19
    v_and_b32 v19, 0xffff0000, v18
    v_lshlrev_b32 v18, 16, v18
    v_add_f32 v17, v17, v19
    v_add_f32 v16, v16, v18
    v_lshlrev_b32 v18, 16, v71
    v_and_b32 v19, 0xffff0000, v71
    v_lshlrev_b32 v20, 16, v107
    v_and_b32 v21, 0xffff0000, v107
    v_mul_f32 v18, v18, v20
    v_mul_f32 v19, v19, v21
    v_cvt_pk_bf16_f32 v18, v18, v19
    v_and_b32 v19, 0xffff0000, v18
    v_lshlrev_b32 v18, 16, v18
    v_add_f32 v17, v17, v19
    v_add_f32 v16, v16, v18
    v_lshlrev_b32 v18, 16, v72
    v_and_b32 v19, 0xffff0000, v72
    v_lshlrev_b32 v20, 16, v108
    v_and_b32 v21, 0xffff0000, v108
    v_mul_f32 v18, v18, v20
    v_mul_f32 v19, v19, v21
    v_cvt_pk_bf16_f32 v18, v18, v19
    v_and_b32 v19, 0xffff0000, v18
    v_lshlrev_b32 v18, 16, v18
    v_add_f32 v17, v17, v19
    v_add_f32 v16, v16, v18
    v_lshlrev_b32 v18, 16, v73
    v_and_b32 v19, 0xffff0000, v73
    v_lshlrev_b32 v20, 16, v109
    v_and_b32 v21, 0xffff0000, v109
    v_mul_f32 v18, v18, v20
    v_mul_f32 v19, v19, v21
    v_cvt_pk_bf16_f32 v18, v18, v19
    v_and_b32 v19, 0xffff0000, v18
    v_lshlrev_b32 v18, 16, v18
    v_add_f32 v17, v17, v19
    v_add_f32 v16, v16, v18
    v_lshlrev_b32 v18, 16, v74
    v_and_b32 v19, 0xffff0000, v74
    v_lshlrev_b32 v20, 16, v110
    v_and_b32 v21, 0xffff0000, v110
    v_mul_f32 v18, v18, v20
    v_mul_f32 v19, v19, v21
    v_cvt_pk_bf16_f32 v18, v18, v19
    v_and_b32 v19, 0xffff0000, v18
    v_lshlrev_b32 v18, 16, v18
    v_add_f32 v17, v17, v19
    v_add_f32 v16, v16, v18
    v_lshlrev_b32 v18, 16, v75
    v_and_b32 v19, 0xffff0000, v75
    v_lshlrev_b32 v20, 16, v111
    v_and_b32 v21, 0xffff0000, v111
    v_mul_f32 v18, v18, v20
    v_mul_f32 v19, v19, v21
    v_cvt_pk_bf16_f32 v18, v18, v19
    v_and_b32 v19, 0xffff0000, v18
    v_lshlrev_b32 v18, 16, v18
    v_add_f32 v17, v17, v19
    v_add_f32 v16, v16, v18
    v_lshlrev_b32 v18, 16, v76
    v_and_b32 v19, 0xffff0000, v76
    v_lshlrev_b32 v20, 16, v112
    v_and_b32 v21, 0xffff0000, v112
    v_mul_f32 v18, v18, v20
    v_mul_f32 v19, v19, v21
    v_cvt_pk_bf16_f32 v18, v18, v19
    v_and_b32 v19, 0xffff0000, v18
    v_lshlrev_b32 v18, 16, v18
    v_add_f32 v17, v17, v19
    v_add_f32 v16, v16, v18
    v_lshlrev_b32 v18, 16, v77
    v_and_b32 v19, 0xffff0000, v77
    v_lshlrev_b32 v20, 16, v113
    v_and_b32 v21, 0xffff0000, v113
    v_mul_f32 v18, v18, v20
    v_mul_f32 v19, v19, v21
    v_cvt_pk_bf16_f32 v18, v18, v19
    v_and_b32 v19, 0xffff0000, v18
    v_lshlrev_b32 v18, 16, v18
    v_add_f32 v17, v17, v19
    v_add_f32 v16, v16, v18
    v_lshlrev_b32 v18, 16, v78
    v_and_b32 v19, 0xffff0000, v78
    v_lshlrev_b32 v20, 16, v114
    v_and_b32 v21, 0xffff0000, v114
    v_mul_f32 v18, v18, v20
    v_mul_f32 v19, v19, v21
    v_cvt_pk_bf16_f32 v18, v18, v19
    v_and_b32 v19, 0xffff0000, v18
    v_lshlrev_b32 v18, 16, v18
    v_add_f32 v17, v17, v19
    v_add_f32 v16, v16, v18
    v_lshlrev_b32 v18, 16, v79
    v_and_b32 v19, 0xffff0000, v79
    v_lshlrev_b32 v20, 16, v115
    v_and_b32 v21, 0xffff0000, v115
    v_mul_f32 v18, v18, v20
    v_mul_f32 v19, v19, v21
    v_cvt_pk_bf16_f32 v18, v18, v19
    v_and_b32 v19, 0xffff0000, v18
    v_lshlrev_b32 v18, 16, v18
    v_add_f32 v17, v17, v19
    v_add_f32 v16, v16, v18
    v_lshlrev_b32 v18, 16, v80
    v_and_b32 v19, 0xffff0000, v80
    v_lshlrev_b32 v20, 16, v116
    v_and_b32 v21, 0xffff0000, v116
    v_mul_f32 v18, v18, v20
    v_mul_f32 v19, v19, v21
    v_cvt_pk_bf16_f32 v18, v18, v19
    v_and_b32 v19, 0xffff0000, v18
    v_lshlrev_b32 v18, 16, v18
    v_add_f32 v17, v17, v19
    v_add_f32 v16, v16, v18
    v_lshlrev_b32 v18, 16, v81
    v_and_b32 v19, 0xffff0000, v81
    v_lshlrev_b32 v20, 16, v117
    v_and_b32 v21, 0xffff0000, v117
    v_mul_f32 v18, v18, v20
    v_mul_f32 v19, v19, v21
    v_cvt_pk_bf16_f32 v18, v18, v19
    v_and_b32 v19, 0xffff0000, v18
    v_lshlrev_b32 v18, 16, v18
    v_add_f32 v17, v17, v19
    v_add_f32 v16, v16, v18
    v_lshlrev_b32 v18, 16, v82
    v_and_b32 v19, 0xffff0000, v82
    v_lshlrev_b32 v20, 16, v118
    v_and_b32 v21, 0xffff0000, v118
    v_mul_f32 v18, v18, v20
    v_mul_f32 v19, v19, v21
    v_cvt_pk_bf16_f32 v18, v18, v19
    v_and_b32 v19, 0xffff0000, v18
    v_lshlrev_b32 v18, 16, v18
    v_add_f32 v17, v17, v19
    v_add_f32 v16, v16, v18
    v_lshlrev_b32 v18, 16, v83
    v_and_b32 v19, 0xffff0000, v83
    v_lshlrev_b32 v20, 16, v119
    v_and_b32 v21, 0xffff0000, v119
    v_mul_f32 v18, v18, v20
    v_mul_f32 v19, v19, v21
    v_cvt_pk_bf16_f32 v18, v18, v19
    v_and_b32 v19, 0xffff0000, v18
    v_lshlrev_b32 v18, 16, v18
    v_add_f32 v17, v17, v19
    v_add_f32 v16, v16, v18
    v_lshlrev_b32 v18, 16, v84
    v_and_b32 v19, 0xffff0000, v84
    v_lshlrev_b32 v20, 16, v120
    v_and_b32 v21, 0xffff0000, v120
    v_mul_f32 v18, v18, v20
    v_mul_f32 v19, v19, v21
    v_cvt_pk_bf16_f32 v18, v18, v19
    v_and_b32 v19, 0xffff0000, v18
    v_lshlrev_b32 v18, 16, v18
    v_add_f32 v17, v17, v19
    v_add_f32 v16, v16, v18
    v_lshlrev_b32 v18, 16, v85
    v_and_b32 v19, 0xffff0000, v85
    v_lshlrev_b32 v20, 16, v121
    v_and_b32 v21, 0xffff0000, v121
    v_mul_f32 v18, v18, v20
    v_mul_f32 v19, v19, v21
    v_cvt_pk_bf16_f32 v18, v18, v19
    v_and_b32 v19, 0xffff0000, v18
    v_lshlrev_b32 v18, 16, v18
    v_add_f32 v17, v17, v19
    v_add_f32 v16, v16, v18
    v_lshlrev_b32 v18, 16, v86
    v_and_b32 v19, 0xffff0000, v86
    v_lshlrev_b32 v20, 16, v122
    v_and_b32 v21, 0xffff0000, v122
    v_mul_f32 v18, v18, v20
    v_mul_f32 v19, v19, v21
    v_cvt_pk_bf16_f32 v18, v18, v19
    v_and_b32 v19, 0xffff0000, v18
    v_lshlrev_b32 v18, 16, v18
    v_add_f32 v17, v17, v19
    v_add_f32 v16, v16, v18
    v_lshlrev_b32 v18, 16, v87
    v_and_b32 v19, 0xffff0000, v87
    v_lshlrev_b32 v20, 16, v123
    v_and_b32 v21, 0xffff0000, v123
    v_mul_f32 v18, v18, v20
    v_mul_f32 v19, v19, v21
    v_cvt_pk_bf16_f32 v18, v18, v19
    v_and_b32 v19, 0xffff0000, v18
    v_lshlrev_b32 v18, 16, v18
    v_add_f32 v17, v17, v19
    v_add_f32 v16, v16, v18
    v_lshlrev_b32 v18, 16, v88
    v_and_b32 v19, 0xffff0000, v88
    v_lshlrev_b32 v20, 16, v124
    v_and_b32 v21, 0xffff0000, v124
    v_mul_f32 v18, v18, v20
    v_mul_f32 v19, v19, v21
    v_cvt_pk_bf16_f32 v18, v18, v19
    v_and_b32 v19, 0xffff0000, v18
    v_lshlrev_b32 v18, 16, v18
    v_add_f32 v17, v17, v19
    v_add_f32 v16, v16, v18
    v_lshlrev_b32 v18, 16, v89
    v_and_b32 v19, 0xffff0000, v89
    v_lshlrev_b32 v20, 16, v125
    v_and_b32 v21, 0xffff0000, v125
    v_mul_f32 v18, v18, v20
    v_mul_f32 v19, v19, v21
    v_cvt_pk_bf16_f32 v18, v18, v19
    v_and_b32 v19, 0xffff0000, v18
    v_lshlrev_b32 v18, 16, v18
    v_add_f32 v17, v17, v19
    v_add_f32 v16, v16, v18
    v_lshlrev_b32 v18, 16, v90
    v_and_b32 v19, 0xffff0000, v90
    v_lshlrev_b32 v20, 16, v126
    v_and_b32 v21, 0xffff0000, v126
    v_mul_f32 v18, v18, v20
    v_mul_f32 v19, v19, v21
    v_cvt_pk_bf16_f32 v18, v18, v19
    v_and_b32 v19, 0xffff0000, v18
    v_lshlrev_b32 v18, 16, v18
    v_add_f32 v17, v17, v19
    v_add_f32 v16, v16, v18
    v_lshlrev_b32 v18, 16, v91
    v_and_b32 v19, 0xffff0000, v91
    v_lshlrev_b32 v20, 16, v127
    v_and_b32 v21, 0xffff0000, v127
    v_mul_f32 v18, v18, v20
    v_mul_f32 v19, v19, v21
    v_cvt_pk_bf16_f32 v18, v18, v19
    v_and_b32 v19, 0xffff0000, v18
    v_lshlrev_b32 v18, 16, v18
    v_add_f32 v17, v17, v19
    v_add_f32 v16, v16, v18
    v_lshlrev_b32 v18, 16, v92
    v_and_b32 v19, 0xffff0000, v92
    v_lshlrev_b32 v20, 16, v128
    v_and_b32 v21, 0xffff0000, v128
    v_mul_f32 v18, v18, v20
    v_mul_f32 v19, v19, v21
    v_cvt_pk_bf16_f32 v18, v18, v19
    v_and_b32 v19, 0xffff0000, v18
    v_lshlrev_b32 v18, 16, v18
    v_add_f32 v17, v17, v19
    v_add_f32 v16, v16, v18
    v_lshlrev_b32 v18, 16, v93
    v_and_b32 v19, 0xffff0000, v93
    v_lshlrev_b32 v20, 16, v129
    v_and_b32 v21, 0xffff0000, v129
    v_mul_f32 v18, v18, v20
    v_mul_f32 v19, v19, v21
    v_cvt_pk_bf16_f32 v18, v18, v19
    v_and_b32 v19, 0xffff0000, v18
    v_lshlrev_b32 v18, 16, v18
    v_add_f32 v17, v17, v19
    v_add_f32 v16, v16, v18
    v_lshlrev_b32 v18, 16, v94
    v_and_b32 v19, 0xffff0000, v94
    v_lshlrev_b32 v20, 16, v130
    v_and_b32 v21, 0xffff0000, v130
    v_mul_f32 v18, v18, v20
    v_mul_f32 v19, v19, v21
    v_cvt_pk_bf16_f32 v18, v18, v19
    v_and_b32 v19, 0xffff0000, v18
    v_lshlrev_b32 v18, 16, v18
    v_add_f32 v17, v17, v19
    v_add_f32 v16, v16, v18
    v_lshlrev_b32 v18, 16, v95
    v_and_b32 v19, 0xffff0000, v95
    v_lshlrev_b32 v20, 16, v131
    v_and_b32 v21, 0xffff0000, v131
    v_mul_f32 v18, v18, v20
    v_mul_f32 v19, v19, v21
    v_cvt_pk_bf16_f32 v18, v18, v19
    v_and_b32 v19, 0xffff0000, v18
    v_lshlrev_b32 v18, 16, v18
    v_add_f32 v17, v17, v19
    v_add_f32 v16, v16, v18
    v_lshlrev_b32 v18, 16, v96
    v_and_b32 v19, 0xffff0000, v96
    v_lshlrev_b32 v20, 16, v132
    v_and_b32 v21, 0xffff0000, v132
    v_mul_f32 v18, v18, v20
    v_mul_f32 v19, v19, v21
    v_cvt_pk_bf16_f32 v18, v18, v19
    v_and_b32 v19, 0xffff0000, v18
    v_lshlrev_b32 v18, 16, v18
    v_add_f32 v17, v17, v19
    v_add_f32 v16, v16, v18
    v_lshlrev_b32 v18, 16, v97
    v_and_b32 v19, 0xffff0000, v97
    v_lshlrev_b32 v20, 16, v133
    v_and_b32 v21, 0xffff0000, v133
    v_mul_f32 v18, v18, v20
    v_mul_f32 v19, v19, v21
    v_cvt_pk_bf16_f32 v18, v18, v19
    v_and_b32 v19, 0xffff0000, v18
    v_lshlrev_b32 v18, 16, v18
    v_add_f32 v17, v17, v19
    v_add_f32 v16, v16, v18
    v_lshlrev_b32 v18, 16, v98
    v_and_b32 v19, 0xffff0000, v98
    v_lshlrev_b32 v20, 16, v134
    v_and_b32 v21, 0xffff0000, v134
    v_mul_f32 v18, v18, v20
    v_mul_f32 v19, v19, v21
    v_cvt_pk_bf16_f32 v18, v18, v19
    v_and_b32 v19, 0xffff0000, v18
    v_lshlrev_b32 v18, 16, v18
    v_add_f32 v17, v17, v19
    v_add_f32 v16, v16, v18
    v_lshlrev_b32 v18, 16, v99
    v_and_b32 v19, 0xffff0000, v99
    v_lshlrev_b32 v20, 16, v135
    v_and_b32 v21, 0xffff0000, v135
    v_mul_f32 v18, v18, v20
    v_mul_f32 v19, v19, v21
    v_cvt_pk_bf16_f32 v18, v18, v19
    v_and_b32 v19, 0xffff0000, v18
    v_lshlrev_b32 v18, 16, v18
    v_add_f32 v17, v17, v19
    v_add_f32 v16, v16, v18
    v_add_f32 v16, v16, v17
    s_nop 1
    v_add_f32_dpp v16, v16, v16 quad_perm:[1,0,3,2] row_mask:0xf bank_mask:0xf
    s_nop 1
    v_add_f32_dpp v16, v16, v16 quad_perm:[2,3,0,1] row_mask:0xf bank_mask:0xf
    s_nop 1
    v_add_f32_dpp v16, v16, v16 row_half_mirror row_mask:0xf bank_mask:0xf
    v_cvt_pk_bf16_f32 v16, v16, v16
    v_lshlrev_b32 v16, 16, v16
    v_mul_f32 v16, 0xbfb8aa3b, v16
    v_exp_f32 v16, v16
    s_nop 0
    v_add_f32 v16, 1.0, v16
    v_rcp_f32 v16, v16
    s_nop 0
    v_cvt_pk_bf16_f32 v16, v16, v16
    v_lshlrev_b32 v16, 16, v16
    v_sub_f32 v17, 1.0, v16
    v_cvt_pk_bf16_f32 v17, v17, v17
    v_lshlrev_b32 v17, 16, v17
    v_lshlrev_b32 v5, 2, v5
    s_mov_b32 s9, 32768
    s_mov_b32 s10, 40960
    s_mov_b32 exec_lo, 0x01010101
    s_mov_b32 exec_hi, 0x01010101
    buffer_store_dword v16, v5, s[32:35], s9 offen sc1
    buffer_store_dword v17, v5, s[32:35], s10 offen sc1
    s_mov_b64 exec, -1
H_PDONE:
    s_setprio 2
    s_and_b32 s7, s6, 1
    s_lshl_b32 s7, s7, 12
    s_add_u32 s7, s7, 82944
    v_and_b32 v12, 31, v0
    v_lshrrev_b32 v13, 5, v0
    v_bfe_u32 v14, v0, 1, 3
    v_xor_b32 v14, v14, v13
    v_lshlrev_b32 v14, 4, v14
    v_lshl_add_u32 v14, v12, 7, v14
    v_add_u32 v8, s7, v14
    v_xor_b32 v9, 32, v8
    v_xor_b32 v10, 64, v8
    v_xor_b32 v11, 0x60, v8
    v_bfe_u32 v14, v0, 2, 2
    v_lshlrev_b32 v14, 1, v14
    v_add_u32 v14, v14, v13
    v_mul_u32_u24 v14, 288, v14
    v_and_b32 v15, 1, v0
    v_bfe_u32 v16, v0, 1, 1
    v_bfe_u32 v17, v0, 4, 1
    v_lshl_add_u32 v16, v17, 2, v16
    v_lshl_add_u32 v16, v15, 1, v16
    v_lshl_add_u32 v12, v16, 3, v14
    s_lshr_b32 s7, s6, 1
    s_mul_i32 s7, s7, 72
    v_add_u32 v12, s7, v12
    s_lshr_b32 s10, s6, 2
    s_mul_i32 s11, s10, 2432
    v_add_u32 v146, s11, v1
    v_and_b32 v6, 31, v0
    v_lshrrev_b32 v7, 5, v0
    s_add_u32 s7, s11, 1024
    v_lshl_add_u32 v147, v6, 2, s7
    v_mul_u32_u24 v5, 18, v7
    v_add_u32 v5, v5, v6
    s_mov_b32 exec_lo, 0xfffc0000
    s_mov_b32 exec_hi, 0xfffc0000
    v_mov_b32 v5, 37
    s_mov_b32 exec_lo, 0x00440000
    s_mov_b32 exec_hi, 0x00440000
    v_mov_b32 v5, 36
    s_mov_b64 exec, -1
    v_lshlrev_b32 v151, 4, v5
    v_add_u32 v148, s11, v151
    v_mov_b32 v150, v2
    v_bfe_u32 v5, v0, 2, 1
    v_lshlrev_b32 v5, 4, v5
    v_bfe_u32 v7, v0, 3, 2
    v_lshl_add_u32 v5, v7, 2, v5
    v_and_b32 v7, 3, v0
    v_add_u32 v5, v5, v7
    s_and_b32 s7, s6, 1
    s_lshl_b32 s7, s7, 7
    s_add_u32 s7, s7, 161536
    v_lshl_add_u32 v152, v5, 2, s7
    v_mov_b32 v88, 0
    v_mov_b32 v89, 0
    v_mov_b32 v90, 0
    v_mov_b32 v91, 0
    v_mov_b32 v92, 0
    v_mov_b32 v93, 0
    v_mov_b32 v94, 0
    v_mov_b32 v95, 0
    v_mov_b32 v96, 0
    v_mov_b32 v97, 0
    v_mov_b32 v98, 0
    v_mov_b32 v99, 0
    v_mov_b32 v100, 0
    v_mov_b32 v101, 0
    v_mov_b32 v102, 0
    v_mov_b32 v103, 0
    v_mov_b32 v104, 0
    v_mov_b32 v105, 0
    v_mov_b32 v106, 0
    v_mov_b32 v107, 0
    v_mov_b32 v108, 0
    v_mov_b32 v109, 0
    v_mov_b32 v110, 0
    v_mov_b32 v111, 0
    v_mov_b32 v112, 0
    v_mov_b32 v113, 0
    v_mov_b32 v114, 0
    v_mov_b32 v115, 0
    v_mov_b32 v116, 0
    v_mov_b32 v117, 0
    v_mov_b32 v118, 0
    v_mov_b32 v119, 0
    v_mov_b32 v132, 0
    v_mov_b32 v133, 0
    v_mov_b32 v134, 0
    v_mov_b32 v135, 0
    v_mov_b32 v125, 0
    v_mov_b32 v153, 0xdddd
    s_cmp_eq_u32 s10, 0
    s_cselect_b32 s7, 0x101, 1
    v_mov_b32 v157, s7
    s_xor_b32 s7, s6, 0
    s_mul_i32 s12, s7, 3072
    s_add_u32 s12, s12, 115712
    s_cmp_eq_u32 s7, 6
    s_cselect_b32 s12, 94208, s12
    s_cmp_eq_u32 s7, 7
    s_cselect_b32 s12, 156928, s12
    s_xor_b32 s7, s6, 4
    s_mul_i32 s13, s7, 3072
    s_add_u32 s13, s13, 115712
    s_cmp_eq_u32 s7, 6
    s_cselect_b32 s13, 94208, s13
    s_cmp_eq_u32 s7, 7
    s_cselect_b32 s13, 156928, s13
    v_add_u32 v80, s12, v1
    v_add_u32 v81, s13, v1
    s_lshl_b32 s7, s6, 2
    v_add_u32 v82, s7, v2
    v_xor_b32 v83, 16, v82
    s_and_b32 s7, s6, 1
    s_lshl_b32 s8, s4, 1
    s_add_u32 s7, s7, s8
    s_lshl_b32 s7, s7, 5
    s_and_b32 s8, s6, 2
    s_add_u32 s7, s7, s8
    s_add_u32 s7, s7, s10
    s_lshl_b32 s8, s5, 2
    s_add_u32 s7, s7, s8
    s_lshl_b32 s15, s7, 7
    s_add_u32 s15, s15, 65536
    s_lshl_b32 s14, s7, 10
    s_add_u32 s14, s14, 9437184
    s_and_b32 s8, s6, 3
    s_mul_i32 s8, s8, 2560
    v_add_u32 v158, s8, v1
    v_lshl_add_u32 v159, v0, 3, s8
SP_20:
    ds_read_b32 v4, v2 offset:208
    s_waitcnt lgkmcnt(0)
    v_readfirstlane_b32 s24, v4
    s_cmp_ge_u32 s24, 9
    s_cbranch_scc1 SD_21
    s_sleep 0
    s_sub_u32 s72, s72, 1
    s_cbranch_scc0 SP_20
    s_mov_b32 s72, 0
SD_21:
    ds_read_b64_tr_b16 v[32:33], v12 offset:0
    ds_read_b64_tr_b16 v[34:35], v12 offset:144
    ds_read_b128 v[36:39], v8 offset:0
    ds_read_b64_tr_b16 v[40:41], v12 offset:2304
    ds_read_b64_tr_b16 v[42:43], v12 offset:2448
    ds_read_b128 v[44:47], v9 offset:0
    ds_read_b64_tr_b16 v[48:49], v12 offset:4608
    ds_read_b64_tr_b16 v[50:51], v12 offset:4752
    ds_read_b128 v[52:55], v10 offset:0
    ds_read_b64_tr_b16 v[56:57], v12 offset:6912
    ds_read_b64_tr_b16 v[58:59], v12 offset:7056
    ds_read_b128 v[60:63], v11 offset:0
    ds_read_b64_tr_b16 v[64:65], v12 offset:9216
    ds_read_b64_tr_b16 v[66:67], v12 offset:9360
    ds_read_b128 v[68:71], v8 offset:8192
    s_waitcnt lgkmcnt(12)
    v_mfma_f32_32x32x16_bf16 v[16:31], v[32:35], v[36:39], 0
    ds_read_b64_tr_b16 v[32:33], v12 offset:11520
    ds_read_b64_tr_b16 v[34:35], v12 offset:11664
    ds_read_b128 v[36:39], v9 offset:8192
    s_waitcnt lgkmcnt(12)
    v_mfma_f32_32x32x16_bf16 v[16:31], v[40:43], v[44:47], v[16:31]
    ds_read_b32 v15, v2 offset:212
    ds_read_b64_tr_b16 v[40:41], v12 offset:13824
    ds_read_b64_tr_b16 v[42:43], v12 offset:13968
    s_waitcnt lgkmcnt(13)
    ds_read_b128 v[44:47], v10 offset:8192
    s_waitcnt lgkmcnt(13)
    v_mfma_f32_32x32x16_bf16 v[16:31], v[48:51], v[52:55], v[16:31]
    ds_read_b64_tr_b16 v[48:49], v12 offset:16128
    ds_read_b64_tr_b16 v[50:51], v12 offset:16272
    s_waitcnt lgkmcnt(13)
    ds_read_b128 v[52:55], v11 offset:8192
    s_waitcnt lgkmcnt(13)
    v_mfma_f32_32x32x16_bf16 v[16:31], v[56:59], v[60:63], v[16:31]
    s_waitcnt lgkmcnt(6)
    v_readfirstlane_b32 s24, v15
    s_cmp_ge_u32 s24, 4
    s_cbranch_scc1 AC_22
SP_23:
    ds_read_b32 v4, v2 offset:212
    s_waitcnt lgkmcnt(0)
    v_readfirstlane_b32 s24, v4
    s_cmp_ge_u32 s24, 4
    s_cbranch_scc1 SD_24
    s_sleep 1
    s_sub_u32 s72, s72, 1
    s_cbranch_scc0 SP_23
    s_mov_b32 s72, 0
SD_24:
AC_22:
    ds_read_b64_tr_b16 v[56:57], v12 offset:18432
    ds_read_b64_tr_b16 v[58:59], v12 offset:18576
    ds_read_b128 v[60:63], v8 offset:16384
    v_mfma_f32_32x32x16_bf16 v[16:31], v[64:67], v[68:71], v[16:31]
    ds_read_b64_tr_b16 v[64:65], v12 offset:20736
    ds_read_b64_tr_b16 v[66:67], v12 offset:20880
    ds_read_b128 v[68:71], v9 offset:16384
    v_mfma_f32_32x32x16_bf16 v[16:31], v[32:35], v[36:39], v[16:31]
    ds_read_b64_tr_b16 v[32:33], v12 offset:23040
    ds_read_b64_tr_b16 v[34:35], v12 offset:23184
    ds_read_b128 v[36:39], v10 offset:16384
    s_waitcnt lgkmcnt(12)
    v_mfma_f32_32x32x16_bf16 v[16:31], v[40:43], v[44:47], v[16:31]
    ds_read_b64_tr_b16 v[40:41], v12 offset:25344
    ds_read_b64_tr_b16 v[42:43], v12 offset:25488
    ds_read_b128 v[44:47], v11 offset:16384
    s_waitcnt lgkmcnt(12)
    v_mfma_f32_32x32x16_bf16 v[16:31], v[48:51], v[52:55], v[16:31]
    ds_read_b64_tr_b16 v[48:49], v12 offset:27648
    ds_read_b64_tr_b16 v[50:51], v12 offset:27792
    ds_read_b128 v[52:55], v8 offset:24576
    s_waitcnt lgkmcnt(12)
    v_mfma_f32_32x32x16_bf16 v[16:31], v[56:59], v[60:63], v[16:31]
    ds_read_b64_tr_b16 v[56:57], v12 offset:29952
    ds_read_b64_tr_b16 v[58:59], v12 offset:30096
    ds_read_b128 v[60:63], v9 offset:24576
    s_waitcnt lgkmcnt(12)
    v_mfma_f32_32x32x16_bf16 v[16:31], v[64:67], v[68:71], v[16:31]
    ds_read_b32 v15, v2 offset:216
    ds_read_b64_tr_b16 v[64:65], v12 offset:32256
    ds_read_b64_tr_b16 v[66:67], v12 offset:32400
    s_waitcnt lgkmcnt(13)
    ds_read_b128 v[68:71], v10 offset:24576
    s_waitcnt lgkmcnt(13)
    v_mfma_f32_32x32x16_bf16 v[16:31], v[32:35], v[36:39], v[16:31]
    ds_read_b64_tr_b16 v[32:33], v12 offset:34560
    ds_read_b64_tr_b16 v[34:35], v12 offset:34704
    s_waitcnt lgkmcnt(13)
    ds_read_b128 v[36:39], v11 offset:24576
    s_waitcnt lgkmcnt(13)
    v_mfma_f32_32x32x16_bf16 v[16:31], v[40:43], v[44:47], v[16:31]
    s_mov_b64 exec, 1
    ds_add_u32 v2, v3 offset:44
    s_mov_b64 exec, -1
    s_waitcnt lgkmcnt(7)
    v_readfirstlane_b32 s24, v15
    s_cmp_ge_u32 s24, 4
    s_cbranch_scc1 AC_25
SP_26:
    ds_read_b32 v4, v2 offset:216
    s_waitcnt lgkmcnt(0)
    v_readfirstlane_b32 s24, v4
    s_cmp_ge_u32 s24, 4
    s_cbranch_scc1 SD_27
    s_sleep 1
    s_sub_u32 s72, s72, 1
    s_cbranch_scc0 SP_26
    s_mov_b32 s72, 0
SD_27:
AC_25:
    v_add_u32 v8, 32768, v8
    v_add_u32 v9, 32768, v9
    v_add_u32 v10, 32768, v10
    v_add_u32 v11, 32768, v11
    v_add_u32 v12, 36864, v12
    ds_read_b64_tr_b16 v[40:41], v12 offset:0
    ds_read_b64_tr_b16 v[42:43], v12 offset:144
    ds_read_b128 v[44:47], v8 offset:0
    v_mfma_f32_32x32x16_bf16 v[16:31], v[48:51], v[52:55], v[16:31]
    ds_read_b64_tr_b16 v[48:49], v12 offset:2304
    ds_read_b64_tr_b16 v[50:51], v12 offset:2448
    ds_read_b128 v[52:55], v9 offset:0
    v_mfma_f32_32x32x16_bf16 v[16:31], v[56:59], v[60:63], v[16:31]
    ds_read_b64_tr_b16 v[56:57], v12 offset:4608
    ds_read_b64_tr_b16 v[58:59], v12 offset:4752
    s_waitcnt lgkmcnt(13)
    ds_read_b128 v[60:63], v10 offset:0
    s_waitcnt lgkmcnt(13)
    v_mfma_f32_32x32x16_bf16 v[16:31], v[64:67], v[68:71], v[16:31]
    ds_read_b64_tr_b16 v[64:65], v12 offset:6912
    ds_read_b64_tr_b16 v[66:67], v12 offset:7056
    s_waitcnt lgkmcnt(13)
    ds_read_b128 v[68:71], v11 offset:0
    s_waitcnt lgkmcnt(13)
    v_mfma_f32_32x32x16_bf16 v[16:31], v[32:35], v[36:39], v[16:31]
    ds_read_b64_tr_b16 v[32:33], v12 offset:9216
    ds_read_b64_tr_b16 v[34:35], v12 offset:9360
    s_waitcnt lgkmcnt(13)
    ds_read_b128 v[36:39], v8 offset:8192
    s_waitcnt lgkmcnt(12)
    v_mfma_f32_32x32x16_bf16 v[16:31], v[40:43], v[44:47], v[16:31]
    ds_read_b64_tr_b16 v[40:41], v12 offset:11520
    ds_read_b64_tr_b16 v[42:43], v12 offset:11664
    ds_read_b128 v[44:47], v9 offset:8192
    s_waitcnt lgkmcnt(12)
    v_mfma_f32_32x32x16_bf16 v[16:31], v[48:51], v[52:55], v[16:31]
    ds_read_b32 v15, v2 offset:220
    ds_read_b64_tr_b16 v[48:49], v12 offset:13824
    ds_read_b64_tr_b16 v[50:51], v12 offset:13968
    s_waitcnt lgkmcnt(13)
    ds_read_b128 v[52:55], v10 offset:8192
    s_waitcnt lgkmcnt(13)
    v_mfma_f32_32x32x16_bf16 v[16:31], v[56:59], v[60:63], v[16:31]
    ds_read_b64_tr_b16 v[56:57], v12 offset:16128
    ds_read_b64_tr_b16 v[58:59], v12 offset:16272
    s_waitcnt lgkmcnt(13)
    ds_read_b128 v[60:63], v11 offset:8192
    s_waitcnt lgkmcnt(13)
    v_mfma_f32_32x32x16_bf16 v[16:31], v[64:67], v[68:71], v[16:31]
    s_waitcnt lgkmcnt(6)
    v_readfirstlane_b32 s24, v15
    s_cmp_ge_u32 s24, 4
    s_cbranch_scc1 AC_28
SP_29:
    ds_read_b32 v4, v2 offset:220
    s_waitcnt lgkmcnt(0)
    v_readfirstlane_b32 s24, v4
    s_cmp_ge_u32 s24, 4
    s_cbranch_scc1 SD_30
    s_sleep 1
    s_sub_u32 s72, s72, 1
    s_cbranch_scc0 SP_29
    s_mov_b32 s72, 0
SD_30:
AC_28:
    ds_read_b64_tr_b16 v[64:65], v12 offset:18432
    ds_read_b64_tr_b16 v[66:67], v12 offset:18576
    ds_read_b128 v[68:71], v8 offset:16384
    v_mfma_f32_32x32x16_bf16 v[16:31], v[32:35], v[36:39], v[16:31]
    ds_read_b64_tr_b16 v[32:33], v12 offset:20736
    ds_read_b64_tr_b16 v[34:35], v12 offset:20880
    ds_read_b128 v[36:39], v9 offset:16384
    v_mfma_f32_32x32x16_bf16 v[16:31], v[40:43], v[44:47], v[16:31]
    ds_read_b64_tr_b16 v[40:41], v12 offset:23040
    ds_read_b64_tr_b16 v[42:43], v12 offset:23184
    ds_read_b128 v[44:47], v10 offset:16384
    s_waitcnt lgkmcnt(12)
    v_mfma_f32_32x32x16_bf16 v[16:31], v[48:51], v[52:55], v[16:31]
    ds_read_b64_tr_b16 v[48:49], v12 offset:25344
    ds_read_b64_tr_b16 v[50:51], v12 offset:25488
    ds_read_b128 v[52:55], v11 offset:16384
    s_waitcnt lgkmcnt(12)
    v_mfma_f32_32x32x16_bf16 v[16:31], v[56:59], v[60:63], v[16:31]
    s_mov_b64 exec, 1
    ds_add_u32 v2, v3 offset:68
    s_mov_b64 exec, -1
    ds_read_b64_tr_b16 v[56:57], v12 offset:27648
    ds_read_b64_tr_b16 v[58:59], v12 offset:27792
    s_waitcnt lgkmcnt(13)
    ds_read_b128 v[60:63], v8 offset:24576
    s_waitcnt lgkmcnt(13)
    v_mfma_f32_32x32x16_bf16 v[16:31], v[64:67], v[68:71], v[16:31]
    ds_read_b64_tr_b16 v[64:65], v12 offset:29952
    ds_read_b64_tr_b16 v[66:67], v12 offset:30096
    s_waitcnt lgkmcnt(13)
    ds_read_b128 v[68:71], v9 offset:24576
    s_waitcnt lgkmcnt(13)
    v_mfma_f32_32x32x16_bf16 v[16:31], v[32:35], v[36:39], v[16:31]
    ds_read_b32 v15, v2 offset:224
    ds_read_b64_tr_b16 v[32:33], v12 offset:32256
    s_waitcnt lgkmcnt(13)
    ds_read_b64_tr_b16 v[34:35], v12 offset:32400
    ds_read_b128 v[36:39], v10 offset:24576
    s_waitcnt lgkmcnt(14)
    v_mfma_f32_32x32x16_bf16 v[16:31], v[40:43], v[44:47], v[16:31]
    ds_read_b64_tr_b16 v[40:41], v12 offset:34560
    s_waitcnt lgkmcnt(13)
    ds_read_b64_tr_b16 v[42:43], v12 offset:34704
    ds_read_b128 v[44:47], v11 offset:24576
    s_waitcnt lgkmcnt(14)
    v_mfma_f32_32x32x16_bf16 v[16:31], v[48:51], v[52:55], v[16:31]
    s_waitcnt lgkmcnt(6)
    v_readfirstlane_b32 s24, v15
    s_cmp_ge_u32 s24, 4
    s_cbranch_scc1 AC_31
SP_32:
    ds_read_b32 v4, v2 offset:224
    s_waitcnt lgkmcnt(0)
    v_readfirstlane_b32 s24, v4
    s_cmp_ge_u32 s24, 4
    s_cbranch_scc1 SD_33
    s_sleep 1
    s_sub_u32 s72, s72, 1
    s_cbranch_scc0 SP_32
    s_mov_b32 s72, 0
SD_33:
AC_31:
    ds_read_b64_tr_b16 v[48:49], v12 offset:36864
    ds_read_b64_tr_b16 v[50:51], v12 offset:37008
    ds_read_b128 v[52:55], v8 offset:32768
    v_mfma_f32_32x32x16_bf16 v[16:31], v[56:59], v[60:63], v[16:31]
    ds_read_b64_tr_b16 v[56:57], v12 offset:39168
    ds_read_b64_tr_b16 v[58:59], v12 offset:39312
    ds_read_b128 v[60:63], v9 offset:32768
    v_mfma_f32_32x32x16_bf16 v[16:31], v[64:67], v[68:71], v[16:31]
    ds_read_b64_tr_b16 v[64:65], v12 offset:41472
    ds_read_b64_tr_b16 v[66:67], v12 offset:41616
    ds_read_b128 v[68:71], v10 offset:32768
    s_waitcnt lgkmcnt(12)
    v_mfma_f32_32x32x16_bf16 v[16:31], v[32:35], v[36:39], v[16:31]
    ds_read_b64_tr_b16 v[32:33], v12 offset:43776
    ds_read_b64_tr_b16 v[34:35], v12 offset:43920
    ds_read_b128 v[36:39], v11 offset:32768
    s_waitcnt lgkmcnt(12)
    v_mfma_f32_32x32x16_bf16 v[16:31], v[40:43], v[44:47], v[16:31]
    s_waitcnt lgkmcnt(9)
    v_mfma_f32_32x32x16_bf16 v[16:31], v[48:51], v[52:55], v[16:31]
    s_waitcnt lgkmcnt(6)
    v_mfma_f32_32x32x16_bf16 v[16:31], v[56:59], v[60:63], v[16:31]
    ds_read_b32 v15, v2 offset:68
    s_waitcnt lgkmcnt(4)
    v_mfma_f32_32x32x16_bf16 v[16:31], v[64:67], v[68:71], v[16:31]
    s_waitcnt lgkmcnt(1)
    v_mfma_f32_32x32x16_bf16 v[16:31], v[32:35], v[36:39], v[16:31]
    s_mov_b32 s25, 0x3eae1a93
    s_waitcnt lgkmcnt(0)
    v_readfirstlane_b32 s24, v15
    s_cmp_ge_u32 s24, 6
    s_cbranch_scc1 AC_34
SP_35:
    ds_read_b32 v4, v2 offset:68
    s_waitcnt lgkmcnt(0)
    v_readfirstlane_b32 s24, v4
    s_cmp_ge_u32 s24, 6
    s_cbranch_scc1 SD_36
    s_sleep 1
    s_sub_u32 s72, s72, 1
    s_cbranch_scc0 SP_35
    s_mov_b32 s72, 0
SD_36:
AC_34:
    s_nop 7
    v_mul_f32 v16, s25, v16
    v_mul_f32 v17, s25, v17
    v_mul_f32 v18, s25, v18
    v_mul_f32 v19, s25, v19
    v_mul_f32 v20, s25, v20
    v_mul_f32 v21, s25, v21
    v_mul_f32 v22, s25, v22
    v_mul_f32 v23, s25, v23
    v_mul_f32 v24, s25, v24
    v_mul_f32 v25, s25, v25
    v_mul_f32 v26, s25, v26
    v_mul_f32 v27, s25, v27
    v_mul_f32 v28, s25, v28
    v_mul_f32 v29, s25, v29
    v_mul_f32 v30, s25, v30
    v_mul_f32 v31, s25, v31
    v_cvt_pk_bf16_f32 v32, v16, v17
    v_cvt_pk_bf16_f32 v33, v18, v19
    v_cvt_pk_bf16_f32 v34, v20, v21
    v_cvt_pk_bf16_f32 v35, v22, v23
    v_cvt_pk_bf16_f32 v36, v26, v27
    v_cvt_pk_bf16_f32 v37, v28, v29
    v_cvt_pk_bf16_f32 v38, v30, v31
    v_cvt_pk_bf16_f32 v39, v24, v25
    s_mul_i32 s8, s6, 2560
    v_add_u32 v8, s8, v1
    ds_write_b128 v8, v[32:35] offset:45056
    ds_write_b128 v8, v[36:39] offset:46080
    s_waitcnt lgkmcnt(0)
    s_mov_b64 exec, 1
    ds_add_u32 v2, v3 offset:200
    s_mov_b64 exec, -1
    s_branch A_JOIN
F_EX:
    s_setprio 3
    v_lshrrev_b32 v13, 4, v0
    v_and_b32 v15, 15, v0
    v_bfe_u32 v14, v0, 1, 3
    v_xor_b32 v14, v14, v13
    v_lshlrev_b32 v14, 4, v14
    v_lshl_add_u32 v14, v15, 7, v14
    s_and_b32 s7, s6, 1
    s_lshl_b32 s8, s7, 12
    s_add_u32 s8, s8, 82944
    v_add_u32 v8, s8, v14
    v_xor_b32 v9, 64, v8
    v_lshrrev_b32 v14, 1, v13
    v_lshlrev_b32 v14, 3, v14
    v_bfe_u32 v16, v0, 2, 2
    v_lshl_add_u32 v14, v16, 1, v14
    v_and_b32 v16, 1, v13
    v_add_u32 v14, v14, v16
    v_mul_u32_u24 v14, 288, v14
    v_bfe_u32 v16, v0, 1, 1
    v_mul_u32_u24 v16, 72, v16
    v_and_b32 v17, 1, v0
    v_lshl_add_u32 v16, v17, 4, v16
    v_add3_u32 v12, v14, v16, 48
    v_lshrrev_b32 v14, 1, v13
    v_mul_u32_u24 v14, 5120, v14
    v_and_b32 v16, 1, v13
    v_lshl_add_u32 v14, v16, 8, v14
    v_lshl_add_u32 v14, v15, 3, v14
    s_mul_i32 s8, s7, 2560
    v_add_u32 v10, s8, v14
    s_lshr_b32 s10, s6, 2
    s_mul_i32 s11, s10, 2432
    v_add_u32 v146, s11, v1
    v_and_b32 v6, 31, v0
    v_lshrrev_b32 v7, 5, v0
    s_add_u32 s7, s11, 1024
    v_lshl_add_u32 v147, v6, 2, s7
    v_mul_u32_u24 v5, 18, v7
    v_add_u32 v5, v5, v6
    s_mov_b32 exec_lo, 0xfffc0000
    s_mov_b32 exec_hi, 0xfffc0000
    v_mov_b32 v5, 37
    s_mov_b32 exec_lo, 0x00440000
    s_mov_b32 exec_hi, 0x00440000
    v_mov_b32 v5, 36
    s_mov_b64 exec, -1
    v_lshlrev_b32 v151, 4, v5
    v_add_u32 v148, s11, v151
    v_mov_b32 v150, v2
    v_bfe_u32 v5, v0, 2, 1
    v_lshlrev_b32 v5, 4, v5
    v_bfe_u32 v7, v0, 3, 2
    v_lshl_add_u32 v5, v7, 2, v5
    v_and_b32 v7, 3, v0
    v_add_u32 v5, v5, v7
    s_and_b32 s7, s6, 1
    s_lshl_b32 s7, s7, 7
    s_add_u32 s7, s7, 161536
    v_lshl_add_u32 v152, v5, 2, s7
    v_mov_b32 v88, 0
    v_mov_b32 v89, 0
    v_mov_b32 v90, 0
    v_mov_b32 v91, 0
    v_mov_b32 v92, 0
    v_mov_b32 v93, 0
    v_mov_b32 v94, 0
    v_mov_b32 v95, 0
    v_mov_b32 v96, 0
    v_mov_b32 v97, 0
    v_mov_b32 v98, 0
    v_mov_b32 v99, 0
    v_mov_b32 v100, 0
    v_mov_b32 v101, 0
    v_mov_b32 v102, 0
    v_mov_b32 v103, 0
    v_mov_b32 v104, 0
    v_mov_b32 v105, 0
    v_mov_b32 v106, 0
    v_mov_b32 v107, 0
    v_mov_b32 v108, 0
    v_mov_b32 v109, 0
    v_mov_b32 v110, 0
    v_mov_b32 v111, 0
    v_mov_b32 v112, 0
    v_mov_b32 v113, 0
    v_mov_b32 v114, 0
    v_mov_b32 v115, 0
    v_mov_b32 v116, 0
    v_mov_b32 v117, 0
    v_mov_b32 v118, 0
    v_mov_b32 v119, 0
    v_mov_b32 v132, 0
    v_mov_b32 v133, 0
    v_mov_b32 v134, 0
    v_mov_b32 v135, 0
    v_mov_b32 v125, 0
    v_mov_b32 v153, 0xdddd
    s_cmp_eq_u32 s10, 0
    s_cselect_b32 s7, 0x101, 1
    v_mov_b32 v157, s7
    s_xor_b32 s7, s6, 0
    s_mul_i32 s12, s7, 3072
    s_add_u32 s12, s12, 115712
    s_cmp_eq_u32 s7, 6
    s_cselect_b32 s12, 94208, s12
    s_cmp_eq_u32 s7, 7
    s_cselect_b32 s12, 156928, s12
    s_xor_b32 s7, s6, 4
    s_mul_i32 s13, s7, 3072
    s_add_u32 s13, s13, 115712
    s_cmp_eq_u32 s7, 6
    s_cselect_b32 s13, 94208, s13
    s_cmp_eq_u32 s7, 7
    s_cselect_b32 s13, 156928, s13
    v_add_u32 v80, s12, v1
    v_add_u32 v81, s13, v1
    s_lshl_b32 s7, s6, 2
    v_add_u32 v82, s7, v2
    v_xor_b32 v83, 16, v82
    s_and_b32 s7, s6, 1
    s_lshl_b32 s8, s4, 1
    s_add_u32 s7, s7, s8
    s_lshl_b32 s7, s7, 5
    s_and_b32 s8, s6, 2
    s_add_u32 s7, s7, s8
    s_add_u32 s7, s7, s10
    s_lshl_b32 s8, s5, 2
    s_add_u32 s7, s7, s8
    s_lshl_b32 s15, s7, 7
    s_add_u32 s15, s15, 65536
    s_lshl_b32 s14, s7, 10
    s_add_u32 s14, s14, 9437184
    s_and_b32 s8, s6, 3
    s_mul_i32 s8, s8, 2560
    v_add_u32 v158, s8, v1
    v_lshl_add_u32 v159, v0, 3, s8
    s_waitcnt vmcnt(0)
    s_mov_b64 exec, 1
    ds_add_u32 v2, v3 offset:208
    s_mov_b64 exec, -1
SP_37:
    ds_read_b32 v4, v2 offset:208
    s_waitcnt lgkmcnt(0)
    v_readfirstlane_b32 s24, v4
    s_cmp_ge_u32 s24, 9
    s_cbranch_scc1 SD_38
    s_sleep 0
    s_sub_u32 s72, s72, 1
    s_cbranch_scc0 SP_37
    s_mov_b32 s72, 0
SD_38:
    ds_read_b64_tr_b16 v[32:33], v12 offset:0
    ds_read_b64_tr_b16 v[34:35], v12 offset:144
    ds_read_b128 v[36:39], v8 offset:0
    ds_read_b128 v[40:43], v8 offset:2048
    ds_read_b64_tr_b16 v[44:45], v12 offset:4608
    ds_read_b64_tr_b16 v[46:47], v12 offset:4752
    ds_read_b128 v[48:51], v9 offset:0
    ds_read_b128 v[52:55], v9 offset:2048
    ds_read_b64_tr_b16 v[56:57], v12 offset:9216
    ds_read_b64_tr_b16 v[58:59], v12 offset:9360
    ds_read_b128 v[60:63], v8 offset:8192
    ds_read_b128 v[64:67], v8 offset:10240
    ds_read_b32 v15, v2 offset:212
    ds_read_b64_tr_b16 v[68:69], v12 offset:13824
    ds_read_b64_tr_b16 v[70:71], v12 offset:13968
    s_waitcnt lgkmcnt(13)
    ds_read_b128 v[72:75], v9 offset:8192
    ds_read_b128 v[76:79], v9 offset:10240
    s_waitcnt lgkmcnt(13)
    v_mfma_f32_16x16x32_bf16 v[16:19], v[32:35], v[36:39], 0
    v_mfma_f32_16x16x32_bf16 v[20:23], v[32:35], v[40:43], 0
    s_waitcnt lgkmcnt(4)
    v_readfirstlane_b32 s24, v15
    s_cmp_ge_u32 s24, 4
    s_cbranch_scc1 AC_39
SP_40:
    ds_read_b32 v4, v2 offset:212
    s_waitcnt lgkmcnt(0)
    v_readfirstlane_b32 s24, v4
    s_cmp_ge_u32 s24, 4
    s_cbranch_scc1 SD_41
    s_sleep 1
    s_sub_u32 s72, s72, 1
    s_cbranch_scc0 SP_40
    s_mov_b32 s72, 0
SD_41:
AC_39:
    ds_read_b64_tr_b16 v[32:33], v12 offset:18432
    ds_read_b64_tr_b16 v[34:35], v12 offset:18576
    ds_read_b128 v[36:39], v8 offset:16384
    ds_read_b128 v[40:43], v8 offset:18432
    v_mfma_f32_16x16x32_bf16 v[16:19], v[44:47], v[48:51], v[16:19]
    v_mfma_f32_16x16x32_bf16 v[20:23], v[44:47], v[52:55], v[20:23]
    ds_read_b64_tr_b16 v[44:45], v12 offset:23040
    ds_read_b64_tr_b16 v[46:47], v12 offset:23184
    ds_read_b128 v[48:51], v9 offset:16384
    ds_read_b128 v[52:55], v9 offset:18432
    v_mfma_f32_16x16x32_bf16 v[16:19], v[56:59], v[60:63], v[16:19]
    v_mfma_f32_16x16x32_bf16 v[20:23], v[56:59], v[64:67], v[20:23]
    ds_read_b32 v15, v2 offset:216
    ds_read_b64_tr_b16 v[56:57], v12 offset:27648
    ds_read_b64_tr_b16 v[58:59], v12 offset:27792
    s_waitcnt lgkmcnt(13)
    ds_read_b128 v[60:63], v8 offset:24576
    ds_read_b128 v[64:67], v8 offset:26624
    s_waitcnt lgkmcnt(13)
    v_mfma_f32_16x16x32_bf16 v[16:19], v[68:71], v[72:75], v[16:19]
    v_mfma_f32_16x16x32_bf16 v[20:23], v[68:71], v[76:79], v[20:23]
    ds_read_b64_tr_b16 v[68:69], v12 offset:32256
    ds_read_b64_tr_b16 v[70:71], v12 offset:32400
    s_waitcnt lgkmcnt(13)
    ds_read_b128 v[72:75], v9 offset:24576
    ds_read_b128 v[76:79], v9 offset:26624
    s_waitcnt lgkmcnt(13)
    v_mfma_f32_16x16x32_bf16 v[16:19], v[32:35], v[36:39], v[16:19]
    v_mfma_f32_16x16x32_bf16 v[20:23], v[32:35], v[40:43], v[20:23]
    s_waitcnt lgkmcnt(8)
    v_readfirstlane_b32 s24, v15
    s_cmp_ge_u32 s24, 4
    s_cbranch_scc1 AC_42
SP_43:
    ds_read_b32 v4, v2 offset:216
    s_waitcnt lgkmcnt(0)
    v_readfirstlane_b32 s24, v4
    s_cmp_ge_u32 s24, 4
    s_cbranch_scc1 SD_44
    s_sleep 1
    s_sub_u32 s72, s72, 1
    s_cbranch_scc0 SP_43
    s_mov_b32 s72, 0
SD_44:
AC_42:
    v_add_u32 v8, 32768, v8
    v_add_u32 v9, 32768, v9
    v_add_u32 v12, 36864, v12
    ds_read_b64_tr_b16 v[32:33], v12 offset:0
    ds_read_b64_tr_b16 v[34:35], v12 offset:144
    ds_read_b128 v[36:39], v8 offset:0
    ds_read_b128 v[40:43], v8 offset:2048
    v_mfma_f32_16x16x32_bf16 v[16:19], v[44:47], v[48:51], v[16:19]
    v_mfma_f32_16x16x32_bf16 v[20:23], v[44:47], v[52:55], v[20:23]
    s_mov_b64 exec, 1
    ds_add_u32 v2, v3 offset:44
    s_mov_b64 exec, -1
    ds_read_b64_tr_b16 v[44:45], v12 offset:4608
    ds_read_b64_tr_b16 v[46:47], v12 offset:4752
    s_waitcnt lgkmcnt(13)
    ds_read_b128 v[48:51], v9 offset:0
    ds_read_b128 v[52:55], v9 offset:2048
    s_waitcnt lgkmcnt(13)
    v_mfma_f32_16x16x32_bf16 v[16:19], v[56:59], v[60:63], v[16:19]
    v_mfma_f32_16x16x32_bf16 v[20:23], v[56:59], v[64:67], v[20:23]
    ds_read_b32 v15, v2 offset:220
    ds_read_b64_tr_b16 v[56:57], v12 offset:9216
    s_waitcnt lgkmcnt(13)
    ds_read_b64_tr_b16 v[58:59], v12 offset:9360
    ds_read_b128 v[60:63], v8 offset:8192
    s_waitcnt lgkmcnt(13)
    ds_read_b128 v[64:67], v8 offset:10240
    v_mfma_f32_16x16x32_bf16 v[16:19], v[68:71], v[72:75], v[16:19]
    v_mfma_f32_16x16x32_bf16 v[20:23], v[68:71], v[76:79], v[20:23]
    ds_read_b64_tr_b16 v[68:69], v12 offset:13824
    s_waitcnt lgkmcnt(13)
    ds_read_b64_tr_b16 v[70:71], v12 offset:13968
    ds_read_b128 v[72:75], v9 offset:8192
    s_waitcnt lgkmcnt(13)
    ds_read_b128 v[76:79], v9 offset:10240
    v_mfma_f32_16x16x32_bf16 v[16:19], v[32:35], v[36:39], v[16:19]
    v_mfma_f32_16x16x32_bf16 v[20:23], v[32:35], v[40:43], v[20:23]
    s_waitcnt lgkmcnt(8)
    v_readfirstlane_b32 s24, v15
    s_cmp_ge_u32 s24, 4
    s_cbranch_scc1 AC_45
SP_46:
    ds_read_b32 v4, v2 offset:220
    s_waitcnt lgkmcnt(0)
    v_readfirstlane_b32 s24, v4
    s_cmp_ge_u32 s24, 4
    s_cbranch_scc1 SD_47
    s_sleep 1
    s_sub_u32 s72, s72, 1
    s_cbranch_scc0 SP_46
    s_mov_b32 s72, 0
SD_47:
AC_45:
    ds_read_b64_tr_b16 v[32:33], v12 offset:18432
    ds_read_b64_tr_b16 v[34:35], v12 offset:18576
    ds_read_b128 v[36:39], v8 offset:16384
    ds_read_b128 v[40:43], v8 offset:18432
    v_mfma_f32_16x16x32_bf16 v[16:19], v[44:47], v[48:51], v[16:19]
    v_mfma_f32_16x16x32_bf16 v[20:23], v[44:47], v[52:55], v[20:23]
    ds_read_b64_tr_b16 v[44:45], v12 offset:23040
    ds_read_b64_tr_b16 v[46:47], v12 offset:23184
    ds_read_b128 v[48:51], v9 offset:16384
    s_waitcnt lgkmcnt(13)
    ds_read_b128 v[52:55], v9 offset:18432
    s_waitcnt lgkmcnt(12)
    v_mfma_f32_16x16x32_bf16 v[16:19], v[56:59], v[60:63], v[16:19]
    v_mfma_f32_16x16x32_bf16 v[20:23], v[56:59], v[64:67], v[20:23]
    ds_read_b32 v15, v2 offset:224
    ds_read_b64_tr_b16 v[56:57], v12 offset:27648
    ds_read_b64_tr_b16 v[58:59], v12 offset:27792
    s_waitcnt lgkmcnt(13)
    ds_read_b128 v[60:63], v8 offset:24576
    ds_read_b128 v[64:67], v8 offset:26624
    s_waitcnt lgkmcnt(13)
    v_mfma_f32_16x16x32_bf16 v[16:19], v[68:71], v[72:75], v[16:19]
    v_mfma_f32_16x16x32_bf16 v[20:23], v[68:71], v[76:79], v[20:23]
    s_mov_b64 exec, 1
    ds_add_u32 v2, v3 offset:68
    s_mov_b64 exec, -1
    ds_read_b64_tr_b16 v[68:69], v12 offset:32256
    s_waitcnt lgkmcnt(13)
    ds_read_b64_tr_b16 v[70:71], v12 offset:32400
    ds_read_b128 v[72:75], v9 offset:24576
    s_waitcnt lgkmcnt(13)
    ds_read_b128 v[76:79], v9 offset:26624
    v_mfma_f32_16x16x32_bf16 v[16:19], v[32:35], v[36:39], v[16:19]
    v_mfma_f32_16x16x32_bf16 v[20:23], v[32:35], v[40:43], v[20:23]
    s_waitcnt lgkmcnt(9)
    v_readfirstlane_b32 s24, v15
    s_cmp_ge_u32 s24, 4
    s_cbranch_scc1 AC_48
SP_49:
    ds_read_b32 v4, v2 offset:224
    s_waitcnt lgkmcnt(0)
    v_readfirstlane_b32 s24, v4
    s_cmp_ge_u32 s24, 4
    s_cbranch_scc1 SD_50
    s_sleep 1
    s_sub_u32 s72, s72, 1
    s_cbranch_scc0 SP_49
    s_mov_b32 s72, 0
SD_50:
AC_48:
    ds_read_b64_tr_b16 v[32:33], v12 offset:36864
    ds_read_b64_tr_b16 v[34:35], v12 offset:37008
    ds_read_b128 v[36:39], v8 offset:32768
    ds_read_b128 v[40:43], v8 offset:34816
    v_mfma_f32_16x16x32_bf16 v[16:19], v[44:47], v[48:51], v[16:19]
    v_mfma_f32_16x16x32_bf16 v[20:23], v[44:47], v[52:55], v[20:23]
    ds_read_b64_tr_b16 v[44:45], v12 offset:41472
    ds_read_b64_tr_b16 v[46:47], v12 offset:41616
    s_waitcnt lgkmcnt(13)
    ds_read_b128 v[48:51], v9 offset:32768
    ds_read_b128 v[52:55], v9 offset:34816
    s_waitcnt lgkmcnt(13)
    v_mfma_f32_16x16x32_bf16 v[16:19], v[56:59], v[60:63], v[16:19]
    v_mfma_f32_16x16x32_bf16 v[20:23], v[56:59], v[64:67], v[20:23]
    s_waitcnt lgkmcnt(8)
    v_mfma_f32_16x16x32_bf16 v[16:19], v[68:71], v[72:75], v[16:19]
    v_mfma_f32_16x16x32_bf16 v[20:23], v[68:71], v[76:79], v[20:23]
    ds_read_b32 v15, v2 offset:68
    s_waitcnt lgkmcnt(5)
    v_mfma_f32_16x16x32_bf16 v[16:19], v[32:35], v[36:39], v[16:19]
    v_mfma_f32_16x16x32_bf16 v[20:23], v[32:35], v[40:43], v[20:23]
    s_waitcnt lgkmcnt(1)
    v_mfma_f32_16x16x32_bf16 v[16:19], v[44:47], v[48:51], v[16:19]
    v_mfma_f32_16x16x32_bf16 v[20:23], v[44:47], v[52:55], v[20:23]
    s_mov_b32 s25, 0x3eae1a93
    s_waitcnt lgkmcnt(0)
    v_readfirstlane_b32 s24, v15
    s_cmp_ge_u32 s24, 6
    s_cbranch_scc1 AC_51
SP_52:
    ds_read_b32 v4, v2 offset:68
    s_waitcnt lgkmcnt(0)
    v_readfirstlane_b32 s24, v4
    s_cmp_ge_u32 s24, 6
    s_cbranch_scc1 SD_53
    s_sleep 1
    s_sub_u32 s72, s72, 1
    s_cbranch_scc0 SP_52
    s_mov_b32 s72, 0
SD_53:
AC_51:
    s_nop 3
    v_mul_f32 v16, s25, v16
    v_mul_f32 v17, s25, v17
    v_mul_f32 v18, s25, v18
    v_mul_f32 v19, s25, v19
    v_mul_f32 v20, s25, v20
    v_mul_f32 v21, s25, v21
    v_mul_f32 v22, s25, v22
    v_mul_f32 v23, s25, v23
    v_cvt_pk_bf16_f32 v32, v16, v17
    v_cvt_pk_bf16_f32 v33, v18, v19
    v_cvt_pk_bf16_f32 v34, v20, v21
    v_cvt_pk_bf16_f32 v35, v22, v23
    ds_write_b64 v10, v[32:33] offset:47104
    ds_write_b64 v10, v[34:35] offset:47232
    s_waitcnt lgkmcnt(0)
    s_mov_b64 exec, 1
    ds_add_u32 v2, v3 offset:200
    s_mov_b64 exec, -1
A_JOIN:
    s_setprio 0
    ds_read_b64 v[6:7], v2 offset:200
    s_waitcnt lgkmcnt(0)
    v_readfirstlane_b32 s24, v6
    v_readfirstlane_b32 s25, v7
    s_add_u32 s24, s24, s25
    s_cmp_ge_u32 s24, 8
    s_cbranch_scc1 A_GO
    s_sleep 1
    s_sub_u32 s72, s72, 1
    s_cbranch_scc0 A_JOIN
    s_mov_b32 s72, 0
A_GO:
    s_setprio 2
    ds_read_b128 v[120:123], v146
    ds_read_b128 v[136:139], v158 offset:45056
    ds_read_b128 v[140:143], v158 offset:46080
    ds_read_b64 v[144:145], v159 offset:47104
    ds_read_b32 v124, v147
    ds_read_b32 v6, v2 offset:192
    ds_read_b128 v[128:131], v148 offset:1152
    v_mov_b32 v64, 0
    v_mov_b32 v65, 0
    v_mov_b32 v66, 0
    v_mov_b32 v67, 0
    v_mov_b32 v68, 0
    v_mov_b32 v69, 0
    v_mov_b32 v70, 0
    v_mov_b32 v71, 0
    s_mov_b32 s20, 0
    s_mov_b32 s22, 19456
    s_waitcnt lgkmcnt(5)
    v_mfma_f32_32x32x16_bf16 v[8:23], v[120:123], v[136:139], 0
    s_waitcnt lgkmcnt(1)
    v_mov_b32 v5, v143
    v_mov_b32 v143, v144
    v_mov_b32 v144, v145
    v_mov_b32 v145, 0
    v_mfma_f32_32x32x16_bf16 v[24:39], v[120:123], v[140:143], 0
    s_mov_b32 exec_hi, 0
    v_mov_b32 v144, v5
    s_mov_b64 exec, -1
    ds_read_b128 v[120:123], v146 offset:4864
    v_readfirstlane_b32 s73, v6
    s_waitcnt vmcnt(0)
    s_mov_b64 exec, 1
    ds_add_u32 v2, v3 offset:0
    s_mov_b64 exec, -1
    s_nop 1
    v_mfma_f32_32x32x4_2b_bf16 v[8:39], v[124:125], v[144:145], v[8:39]
    ds_read_b32 v124, v147 offset:4864
    s_cmp_lt_u32 s6, 6
    s_cbranch_scc1 A_NOC1
    s_mov_b64 exec, 1
    v_mov_b32 v5, 0x8000
    ds_add_u32 v2, v5 offset:4
    s_mov_b64 exec, -1
A_NOC1:
    s_cmp_lg_u32 s10, 0
    s_cbranch_scc1 A_NO1B
SP_54:
    ds_read_b32 v4, v2 offset:0
    s_waitcnt lgkmcnt(0)
    v_readfirstlane_b32 s24, v4
    s_cmp_ge_u32 s24, 8
    s_cbranch_scc1 SD_55
    s_sleep 0
    s_sub_u32 s72, s72, 1
    s_cbranch_scc0 SP_54
    s_mov_b32 s72, 0
SD_55:
    s_lshl_b32 s7, s6, 10
    s_add_u32 s8, s7, 565248
    s_add_u32 m0, s7, 40960
    s_nop 0
    buffer_load_dwordx4 v1, s[32:35], s8 offen sc1 lds
    s_add_u32 s8, s8, 4096
    s_add_u32 m0, s7, 45056
    s_nop 0
    buffer_load_dwordx4 v1, s[32:35], s8 offen sc1 lds
    s_add_u32 s8, s8, 4096
    s_add_u32 m0, s7, 49152
    s_nop 0
    buffer_load_dwordx4 v1, s[32:35], s8 offen sc1 lds
    s_add_u32 s8, s8, 4096
    s_add_u32 m0, s7, 53248
    s_nop 0
    buffer_load_dwordx4 v1, s[32:35], s8 offen sc1 lds
    s_add_u32 s8, s8, 4096
    s_add_u32 m0, s7, 57344
    s_nop 0
    buffer_load_dwordx4 v1, s[32:35], s8 offen sc1 lds
    s_add_u32 s8, s8, 4096
    s_add_u32 m0, s7, 61440
    s_nop 0
    buffer_load_dwordx4 v1, s[32:35], s8 offen sc1 lds
    s_add_u32 s8, s8, 4096
    s_add_u32 m0, s7, 65536
    s_nop 0
    buffer_load_dwordx4 v1, s[32:35], s8 offen sc1 lds
    s_add_u32 s8, s8, 4096
    s_add_u32 m0, s7, 69632
    s_nop 0
    buffer_load_dwordx4 v1, s[32:35], s8 offen sc1 lds
    s_add_u32 s8, s8, 4096
    s_add_u32 m0, s7, 73728
    s_nop 0
    buffer_load_dwordx4 v1, s[32:35], s8 offen sc1 lds
    s_add_u32 s8, s8, 4096
A_NO1B:
    s_waitcnt lgkmcnt(0)
    s_nop 13
.p2align 6
A_LOOP:
    s_setprio 2
    v_exp_f32 v8, v8
    v_exp_f32 v9, v9
    v_smfmac_f32_32x32x32_bf16 v[104:119], v[132:135], v[64:71], v153
    ds_read_b128 v[132:135], v148 offset:1792
    v_exp_f32 v10, v10
    v_exp_f32 v11, v11
    v_exp_f32 v12, v12
    v_mfma_f32_32x32x4_2b_bf16 v[40:71], v[124:125], v[144:145], 0
    ds_read_b32 v124, v147 offset:9728
    v_exp_f32 v13, v13
    v_exp_f32 v14, v14
    v_exp_f32 v15, v15
    v_exp_f32 v24, v24
    v_exp_f32 v25, v25
    v_exp_f32 v26, v26
    v_exp_f32 v27, v27
    v_exp_f32 v28, v28
    v_exp_f32 v29, v29
    s_waitcnt lgkmcnt(2)
    v_smfmac_f32_32x32x32_bf16 v[88:103], v[128:131], v[8:15], v153
    v_exp_f32 v30, v30
    v_exp_f32 v31, v31
    v_exp_f32 v16, v16
    v_exp_f32 v17, v17
    v_smfmac_f32_32x32x32_bf16 v[104:119], v[128:131], v[24:31], v153
    ds_read_b128 v[128:131], v148 offset:6016
    v_exp_f32 v18, v18
    v_exp_f32 v19, v19
    v_exp_f32 v20, v20
    v_exp_f32 v21, v21
    v_mfma_f32_32x32x16_bf16 v[40:55], v[120:123], v[136:139], v[40:55]
    v_exp_f32 v22, v22
    v_exp_f32 v23, v23
    v_exp_f32 v32, v32
    v_mfma_f32_32x32x16_bf16 v[56:71], v[120:123], v[140:143], v[56:71]
    ds_read_b128 v[120:123], v146 offset:9728
    v_exp_f32 v33, v33
    v_exp_f32 v34, v34
    v_exp_f32 v35, v35
    v_exp_f32 v36, v36
    s_waitcnt lgkmcnt(2)
    v_smfmac_f32_32x32x32_bf16 v[88:103], v[132:135], v[16:23], v153
    v_exp_f32 v37, v37
    v_exp_f32 v38, v38
    v_exp_f32 v39, v39
    s_setprio 2
    v_exp_f32 v40, v40
    v_exp_f32 v41, v41
    v_smfmac_f32_32x32x32_bf16 v[104:119], v[132:135], v[32:39], v153
    ds_read_b32 v149, v150 offset:4
    ds_read_b128 v[132:135], v148 offset:6656
    v_exp_f32 v42, v42
    v_exp_f32 v43, v43
    v_exp_f32 v44, v44
    v_mfma_f32_32x32x4_2b_bf16 v[8:39], v[124:125], v[144:145], 0
    ds_read_b32 v124, v147 offset:14592
    v_exp_f32 v45, v45
    v_exp_f32 v46, v46
    v_exp_f32 v47, v47
    v_exp_f32 v56, v56
    v_exp_f32 v57, v57
    v_exp_f32 v58, v58
    v_exp_f32 v59, v59
    v_exp_f32 v60, v60
    v_exp_f32 v61, v61
    s_waitcnt lgkmcnt(2)
    v_smfmac_f32_32x32x32_bf16 v[88:103], v[128:131], v[40:47], v153
    v_exp_f32 v62, v62
    v_exp_f32 v63, v63
    v_exp_f32 v48, v48
    v_exp_f32 v49, v49
    v_smfmac_f32_32x32x32_bf16 v[104:119], v[128:131], v[56:63], v153
    ds_read_b128 v[128:131], v148 offset:10880
    v_exp_f32 v50, v50
    v_exp_f32 v51, v51
    v_exp_f32 v52, v52
    v_exp_f32 v53, v53
    v_mfma_f32_32x32x16_bf16 v[8:23], v[120:123], v[136:139], v[8:23]
    v_exp_f32 v54, v54
    v_exp_f32 v55, v55
    v_exp_f32 v64, v64
    v_mfma_f32_32x32x16_bf16 v[24:39], v[120:123], v[140:143], v[24:39]
    ds_read_b128 v[120:123], v146 offset:14592
    v_exp_f32 v65, v65
    v_exp_f32 v66, v66
    v_exp_f32 v67, v67
    v_exp_f32 v68, v68
    s_waitcnt lgkmcnt(2)
    v_smfmac_f32_32x32x32_bf16 v[88:103], v[132:135], v[48:55], v153
    v_exp_f32 v69, v69
    v_exp_f32 v70, v70
    v_exp_f32 v71, v71
    v_readfirstlane_b32 s24, v149
    s_cmp_eq_u32 s20, 3
    s_cselect_b32 s21, 0xffff1c00, s22
    s_cmp_eq_u32 s20, 4
    s_cselect_b32 s21, 97280, s21
    s_cmp_eq_u32 s20, 7
    s_cselect_b32 s21, 0, s21
    v_add_u32 v146, s21, v146
    v_add_u32 v147, s21, v147
    s_cmp_ge_u32 s20, 6
    s_cselect_b32 s27, 8, 0
    s_and_b32 s25, s24, 0xff
    s_cmp_ge_u32 s25, s27
    s_cbranch_scc0 A_SPIN
    s_cmp_ge_u32 s24, 0x10000
    s_cbranch_scc0 A_SPIN
A_SPUN:
    s_setprio 1
    v_exp_f32 v8, v8
    v_exp_f32 v9, v9
    v_smfmac_f32_32x32x32_bf16 v[104:119], v[132:135], v[64:71], v153
    ds_read_b128 v[132:135], v148 offset:11520
    v_exp_f32 v10, v10
    v_exp_f32 v11, v11
    v_exp_f32 v12, v12
    v_mfma_f32_32x32x4_2b_bf16 v[40:71], v[124:125], v[144:145], 0
    ds_read_b32 v124, v147 offset:0
    v_exp_f32 v13, v13
    v_exp_f32 v14, v14
    v_exp_f32 v15, v15
    v_exp_f32 v24, v24
    v_exp_f32 v25, v25
    v_exp_f32 v26, v26
    v_exp_f32 v27, v27
    v_exp_f32 v28, v28
    v_exp_f32 v29, v29
    s_waitcnt lgkmcnt(2)
    v_smfmac_f32_32x32x32_bf16 v[88:103], v[128:131], v[8:15], v153
    v_exp_f32 v30, v30
    v_exp_f32 v31, v31
    v_exp_f32 v16, v16
    v_exp_f32 v17, v17
    v_smfmac_f32_32x32x32_bf16 v[104:119], v[128:131], v[24:31], v153
    ds_read_b128 v[128:131], v148 offset:15744
    v_exp_f32 v18, v18
    v_exp_f32 v19, v19
    v_exp_f32 v20, v20
    v_exp_f32 v21, v21
    v_mfma_f32_32x32x16_bf16 v[40:55], v[120:123], v[136:139], v[40:55]
    v_exp_f32 v22, v22
    v_exp_f32 v23, v23
    v_exp_f32 v32, v32
    v_mfma_f32_32x32x16_bf16 v[56:71], v[120:123], v[140:143], v[56:71]
    ds_read_b128 v[120:123], v146 offset:0
    v_exp_f32 v33, v33
    v_exp_f32 v34, v34
    v_exp_f32 v35, v35
    v_exp_f32 v36, v36
    s_waitcnt lgkmcnt(2)
    v_smfmac_f32_32x32x32_bf16 v[88:103], v[132:135], v[16:23], v153
    v_exp_f32 v37, v37
    v_exp_f32 v38, v38
    v_exp_f32 v39, v39
    s_setprio 0
    v_exp_f32 v40, v40
    v_exp_f32 v41, v41
    v_smfmac_f32_32x32x32_bf16 v[104:119], v[132:135], v[32:39], v153
    ds_read_b128 v[132:135], v148 offset:16384
    v_exp_f32 v42, v42
    v_exp_f32 v43, v43
    v_exp_f32 v44, v44
    v_mfma_f32_32x32x4_2b_bf16 v[8:39], v[124:125], v[144:145], 0
    ds_read_b32 v124, v147 offset:4864
    v_add_u32 v148, s21, v148
    v_exp_f32 v45, v45
    v_exp_f32 v46, v46
    v_exp_f32 v47, v47
    v_exp_f32 v56, v56
    v_exp_f32 v57, v57
    v_exp_f32 v58, v58
    v_exp_f32 v59, v59
    v_exp_f32 v60, v60
    v_exp_f32 v61, v61
    s_waitcnt lgkmcnt(2)
    v_smfmac_f32_32x32x32_bf16 v[88:103], v[128:131], v[40:47], v153
    v_exp_f32 v62, v62
    v_exp_f32 v63, v63
    v_exp_f32 v48, v48
    v_exp_f32 v49, v49
    v_smfmac_f32_32x32x32_bf16 v[104:119], v[128:131], v[56:63], v153
    ds_read_b128 v[128:131], v148 offset:1152
    v_exp_f32 v50, v50
    v_exp_f32 v51, v51
    v_exp_f32 v52, v52
    v_exp_f32 v53, v53
    v_mfma_f32_32x32x16_bf16 v[8:23], v[120:123], v[136:139], v[8:23]
    v_exp_f32 v54, v54
    v_exp_f32 v55, v55
    v_exp_f32 v64, v64
    v_mfma_f32_32x32x16_bf16 v[24:39], v[120:123], v[140:143], v[24:39]
    ds_read_b128 v[120:123], v146 offset:4864
    v_exp_f32 v65, v65
    v_exp_f32 v66, v66
    v_exp_f32 v67, v67
    v_exp_f32 v68, v68
    s_waitcnt lgkmcnt(2)
    v_smfmac_f32_32x32x32_bf16 v[88:103], v[132:135], v[48:55], v153
    v_exp_f32 v69, v69
    v_exp_f32 v70, v70
    v_exp_f32 v71, v71
    s_waitcnt vmcnt(0)
    s_mov_b64 exec, 1
    ds_add_u32 v150, v157 offset:8
    s_mov_b64 exec, -1
    v_add_u32 v150, 4, v150
    s_add_u32 s20, s20, 1
    s_cmp_lt_u32 s20, 8
    s_cbranch_scc1 A_LOOP
    s_setprio 3
    v_smfmac_f32_32x32x32_bf16 v[104:119], v[132:135], v[64:71], v153
    ds_read_b32 v148, v152
    s_and_b32 s24, s24, 0xff
    s_cmp_ge_u32 s24, 8
    s_cbranch_scc1 A_S6
SP_56:
    ds_read_b32 v4, v2 offset:32
    s_waitcnt lgkmcnt(0)
    v_readfirstlane_b32 s24, v4
    s_and_b32 s24, s24, 0xff
    s_cmp_ge_u32 s24, 8
    s_cbranch_scc1 SD_57
    s_sleep 1
    s_sub_u32 s72, s72, 1
    s_cbranch_scc0 SP_56
    s_mov_b32 s72, 0
SD_57:
A_S6:
    s_mov_b32 s26, 0
    s_cmp_eq_u32 s10, 0
    s_cbranch_scc1 A_C0
    ds_write_b128 v80, v[88:91] offset:0
    ds_write_b128 v80, v[92:95] offset:1024
    ds_write_b128 v80, v[96:99] offset:2048
    s_branch A_C1
A_C0:
    s_nop 4
    ds_write_b128 v80, v[104:107] offset:0
    ds_write_b128 v80, v[108:111] offset:1024
    ds_write_b128 v80, v[112:115] offset:2048
A_C1:
    ds_write_b32 v82, v3 offset:128
A_PW:
    ds_read_b32 v4, v83 offset:128
    ds_read_b128 v[8:11], v81 offset:0
    ds_read_b128 v[12:15], v81 offset:1024
    ds_read_b128 v[16:19], v81 offset:2048
    s_waitcnt lgkmcnt(3)
    v_readfirstlane_b32 s24, v4
    s_cmp_lg_u32 s24, 0
    s_cbranch_scc1 A_PD
    s_sleep 1
    s_sub_u32 s72, s72, 1
    s_cbranch_scc0 A_PW
    s_mov_b32 s72, 0
A_PD:
    s_cmp_eq_u32 s10, 0
    s_waitcnt lgkmcnt(0)
    s_cbranch_scc1 A_A0
    v_add_f32 v98, v114, v18
    v_add_f32 v88, v104, v8
    v_add_f32 v89, v105, v9
    v_add_f32 v90, v106, v10
    v_add_f32 v91, v107, v11
    v_add_f32 v92, v108, v12
    v_add_f32 v93, v109, v13
    v_add_f32 v94, v110, v14
    v_add_f32 v95, v111, v15
    v_add_f32 v96, v112, v16
    v_add_f32 v97, v113, v17
    s_branch A_FIN
A_A0:
    v_add_f32 v98, v98, v18
    v_add_f32 v88, v88, v8
    v_add_f32 v89, v89, v9
    v_add_f32 v90, v90, v10
    v_add_f32 v91, v91, v11
    v_add_f32 v92, v92, v12
    v_add_f32 v93, v93, v13
    v_add_f32 v94, v94, v14
    v_add_f32 v95, v95, v15
    v_add_f32 v96, v96, v16
    v_add_f32 v97, v97, v17
A_FIN:
    v_rcp_f32 v6, v98
    v_lshlrev_b32 v7, 2, v0
    v_mul_f32 v5, v6, v148
    v_mul_f32 v8, v88, v5
    v_mul_f32 v9, v89, v5
    v_mul_f32 v10, v90, v5
    v_mul_f32 v11, v91, v5
    v_mul_f32 v12, v92, v5
    v_mul_f32 v13, v93, v5
    v_mul_f32 v14, v94, v5
    v_mul_f32 v15, v95, v5
    v_mul_f32 v16, v96, v5
    v_mul_f32 v17, v97, v5
    v_cvt_pk_bf16_f32 v72, v8, v9
    v_cvt_pk_bf16_f32 v73, v10, v11
    v_cvt_pk_bf16_f32 v74, v12, v13
    v_cvt_pk_bf16_f32 v75, v14, v15
    v_cvt_pk_bf16_f32 v76, v16, v17
    buffer_store_dwordx4 v[72:75], v1, s[32:35], s14 offen sc1
    s_mov_b32 exec_hi, 0
    buffer_store_dword v76, v7, s[32:35], s15 offen sc1
    s_mov_b64 exec, -1
    s_cmp_lg_u32 s26, 0
    s_cbranch_scc1 A_PUBW
    v_mul_f32 v5, 0, v88
    v_fma_f32 v5, v89, 0, v5
    v_fma_f32 v5, v90, 0, v5
    v_fma_f32 v5, v91, 0, v5
    v_fma_f32 v5, v92, 0, v5
    v_fma_f32 v5, v93, 0, v5
    v_fma_f32 v5, v94, 0, v5
    v_fma_f32 v5, v95, 0, v5
    v_fma_f32 v5, v96, 0, v5
    v_fma_f32 v5, v97, 0, v5
    v_add_f32 v5, v5, v98
    s_mov_b32 s24, 0x2b800000
    s_mov_b32 s25, 0x53800000
    v_cmp_nle_f32 vcc, s24, v5
    v_cmp_nge_f32 s[28:29], s25, v5
    s_nop 1
    s_or_b64 s[28:29], vcc, s[28:29]
    s_cbranch_scc1 A_FALLBACK
A_PUB:
    s_lshl_b32 s9, s4, 10
    s_lshl_b32 s8, s5, 7
    s_add_u32 s9, s9, s8
    s_add_u32 s9, s9, 327680
    s_waitcnt vmcnt(0)
    s_mov_b64 exec, 1
    ds_add_rtn_u32 v4, v2, v3 offset:108
    s_waitcnt lgkmcnt(0)
    v_readfirstlane_b32 s24, v4
    s_mov_b64 exec, -1
    s_cmp_lg_u32 s24, 7
    s_cbranch_scc1 LF_58
    v_lshlrev_b32 v4, 13, v0
    v_mov_b32 v5, s73
    s_mov_b64 exec, 1
    buffer_store_dword v5, v4, s[32:35], s9 offen sc1
    s_mov_b64 exec, -1
LF_58:
    s_endpgm
A_PUBW:
    s_waitcnt vmcnt(0)
    s_branch A_PUB
A_SPIN:
    s_cmp_eq_u32 s72, 0
    s_cbranch_scc1 A_SPUN
    s_sub_u32 s72, s72, 1
    s_sleep 1
    ds_read_b32 v149, v150 offset:4
    s_waitcnt lgkmcnt(0)
    v_readfirstlane_b32 s24, v149
    s_and_b32 s25, s24, 0xff
    s_cmp_ge_u32 s25, s27
    s_cbranch_scc0 A_SPIN
    s_cmp_ge_u32 s24, 0x10000
    s_cbranch_scc0 A_SPIN
    s_branch A_SPUN
A_FALLBACK:
    s_mov_b32 s26, 1
    s_cmp_eq_u32 s10, 0
    s_cbranch_scc1 A_F0
    v_mov_b32 v136, v140
    v_mov_b32 v137, v141
    v_mov_b32 v138, v142
    v_mov_b32 v139, v143
    s_mov_b32 exec_hi, 0
    v_mov_b32 v144, 0
    s_branch A_F1
A_F0:
    s_mov_b32 exec_lo, 0
    v_mov_b32 v144, 0
A_F1:
    s_mov_b64 exec, -1
    v_and_b32 v6, 31, v0
    v_lshlrev_b32 v6, 2, v6
    v_mov_b32 v5, 0xff800000
    s_mov_b32 s24, 524288
A_FMAX:
    buffer_load_dwordx4 v[120:123], v1, s[32:35], s24 offen sc1
    buffer_load_dword v124, v6, s[32:35], s24 offen offset:1024 sc1
    s_waitcnt vmcnt(0)
    v_mfma_f32_32x32x16_bf16 v[8:23], v[120:123], v[136:139], 0
    v_mfma_f32_32x32x8_bf16 v[8:23], v[124:125], v[144:145], v[8:23]
    s_nop 11
    v_max3_f32 v5, v5, v8, v9
    v_max3_f32 v5, v5, v10, v11
    v_max3_f32 v5, v5, v12, v13
    v_max3_f32 v5, v5, v14, v15
    v_max3_f32 v5, v5, v16, v17
    v_max3_f32 v5, v5, v18, v19
    v_max3_f32 v5, v5, v20, v21
    v_max3_f32 v5, v5, v22, v23
    s_add_u32 s24, s24, 2432
    s_cmp_lt_u32 s24, 679936
    s_cbranch_scc1 A_FMAX
    v_mov_b32 v7, v5
    s_nop 1
    v_permlane32_swap_b32 v5, v7
    s_nop 1
    v_max_f32 v5, v5, v7
    v_mov_b32 v88, 0
    v_mov_b32 v89, 0
    v_mov_b32 v90, 0
    v_mov_b32 v91, 0
    v_mov_b32 v92, 0
    v_mov_b32 v93, 0
    v_mov_b32 v94, 0
    v_mov_b32 v95, 0
    v_mov_b32 v96, 0
    v_mov_b32 v97, 0
    v_mov_b32 v98, 0
    v_mov_b32 v99, 0
    v_mov_b32 v100, 0
    v_mov_b32 v101, 0
    v_mov_b32 v102, 0
    v_mov_b32 v103, 0
    s_mov_b32 s24, 524288
A_FSUM:
    buffer_load_dwordx4 v[120:123], v1, s[32:35], s24 offen sc1
    buffer_load_dword v124, v6, s[32:35], s24 offen offset:1024 sc1
    buffer_load_dwordx4 v[128:131], v151, s[32:35], s24 offen offset:1152 sc1
    buffer_load_dwordx4 v[132:135], v151, s[32:35], s24 offen offset:1792 sc1
    s_waitcnt vmcnt(0)
    v_mfma_f32_32x32x16_bf16 v[8:23], v[120:123], v[136:139], 0
    v_mfma_f32_32x32x8_bf16 v[8:23], v[124:125], v[144:145], v[8:23]
    s_nop 11
    v_sub_f32 v8, v8, v5
    v_sub_f32 v9, v9, v5
    v_sub_f32 v10, v10, v5
    v_sub_f32 v11, v11, v5
    v_sub_f32 v12, v12, v5
    v_sub_f32 v13, v13, v5
    v_sub_f32 v14, v14, v5
    v_sub_f32 v15, v15, v5
    v_sub_f32 v16, v16, v5
    v_sub_f32 v17, v17, v5
    v_sub_f32 v18, v18, v5
    v_sub_f32 v19, v19, v5
    v_sub_f32 v20, v20, v5
    v_sub_f32 v21, v21, v5
    v_sub_f32 v22, v22, v5
    v_sub_f32 v23, v23, v5
    v_exp_f32 v8, v8
    v_exp_f32 v9, v9
    v_exp_f32 v10, v10
    v_exp_f32 v11, v11
    v_exp_f32 v12, v12
    v_exp_f32 v13, v13
    v_exp_f32 v14, v14
    v_exp_f32 v15, v15
    v_exp_f32 v16, v16
    v_exp_f32 v17, v17
    v_exp_f32 v18, v18
    v_exp_f32 v19, v19
    v_exp_f32 v20, v20
    v_exp_f32 v21, v21
    v_exp_f32 v22, v22
    v_exp_f32 v23, v23
    s_nop 1
    v_smfmac_f32_32x32x32_bf16 v[88:103], v[128:131], v[8:15], v153
    v_smfmac_f32_32x32x32_bf16 v[88:103], v[132:135], v[16:23], v153
    s_add_u32 s24, s24, 2432
    s_cmp_lt_u32 s24, 679936
    s_cbranch_scc1 A_FSUM
    s_nop 11
    s_branch A_FIN
S_REST:
    s_mul_i32 s16, s8, 36864
    s_add_u32 s16, s16, 688128
    s_lshl_b32 s17, s74, 12
    s_mul_i32 s19, s11, 36864
    s_add_u32 s19, s19, 688128
    s_cmp_lt_u32 s100, 4
    s_cselect_b32 s19, s19, 12582912
    s_cmp_eq_u32 s7, 0
    s_cselect_b32 s19, 12582912, s19
    s_max_u32 s21, s7, 1
    s_sub_u32 s21, s21, 1
    s_mul_i32 s24, s21, 12288
    s_add_u32 s20, s17, s24
    s_cmp_ge_u32 s20, 36864
    s_cselect_b32 s24, 36864, 0
    s_sub_u32 s20, s20, s24
SP_59:
    ds_read_b32 v4, v2 offset:208
    s_waitcnt lgkmcnt(0)
    v_readfirstlane_b32 s24, v4
    s_cmp_ge_u32 s24, 9
    s_cbranch_scc1 SD_60
    s_sleep 1
    s_sub_u32 s72, s72, 1
    s_cbranch_scc0 SP_59
    s_mov_b32 s72, 0
SD_60:
    s_mov_b32 s24, s5
    s_lshr_b32 s25, s7, 1
    s_xor_b32 s25, s25, s101
    s_and_b32 s25, s25, 1
    s_and_b32 s26, s7, 1
    s_lshl_b32 s26, s26, 2
    s_add_u32 s24, s24, 9
    s_sub_u32 s24, s24, s74
    s_cmp_ge_u32 s24, 9
    s_cselect_b32 s27, 9, 0
    s_sub_u32 s24, s24, s27
    s_lshl_b32 s24, s24, 13
    s_lshl_b32 s25, s25, 12
    s_add_u32 s24, s24, s25
    s_add_u32 s24, s24, 82944
    v_bfe_u32 v16, v0, 3, 2
    v_add_u32 v16, s26, v16
    v_lshrrev_b32 v17, 5, v0
    v_lshlrev_b32 v18, 1, v17
    v_xor_b32 v16, v16, v18
    v_lshlrev_b32 v16, 4, v16
    v_lshl_add_u32 v16, v17, 9, v16
    v_and_b32 v17, 7, v0
    v_lshl_add_u32 v16, v17, 1, v16
    v_add_u32 v16, s24, v16
    v_xor_b32 v17, 16, v16
    v_xor_b32 v18, 64, v16
    v_xor_b32 v19, 0x50, v16
    ds_read_u16 v48, v16 offset:0
    ds_read_u16 v49, v16 offset:128
    ds_read_u16 v50, v17 offset:256
    ds_read_u16 v51, v17 offset:384
    ds_read_u16 v52, v18 offset:1024
    ds_read_u16 v53, v18 offset:1152
    ds_read_u16 v54, v19 offset:1280
    ds_read_u16 v55, v19 offset:1408
    s_waitcnt lgkmcnt(4)
    ds_read_u16 v56, v16 offset:2048
    ds_read_u16 v57, v16 offset:2176
    ds_read_u16 v58, v17 offset:2304
    ds_read_u16 v59, v17 offset:2432
    ds_read_u16 v60, v18 offset:3072
    ds_read_u16 v61, v18 offset:3200
    ds_read_u16 v62, v19 offset:3328
    ds_read_u16 v63, v19 offset:3456
    v_lshlrev_b32 v35, 16, v35
    s_waitcnt lgkmcnt(0)
    v_lshlrev_b32 v48, 16, v48
    v_mul_f32 v48, v48, v35
    v_lshlrev_b32 v49, 16, v49
    v_mul_f32 v49, v49, v35
    v_lshlrev_b32 v50, 16, v50
    v_mul_f32 v50, v50, v35
    v_lshlrev_b32 v51, 16, v51
    v_mul_f32 v51, v51, v35
    v_lshlrev_b32 v52, 16, v52
    v_mul_f32 v52, v52, v35
    v_lshlrev_b32 v53, 16, v53
    v_mul_f32 v53, v53, v35
    v_lshlrev_b32 v54, 16, v54
    v_mul_f32 v54, v54, v35
    v_lshlrev_b32 v55, 16, v55
    v_mul_f32 v55, v55, v35
    v_lshlrev_b32 v56, 16, v56
    v_mul_f32 v56, v56, v35
    v_lshlrev_b32 v57, 16, v57
    v_mul_f32 v57, v57, v35
    v_lshlrev_b32 v58, 16, v58
    v_mul_f32 v58, v58, v35
    v_lshlrev_b32 v59, 16, v59
    v_mul_f32 v59, v59, v35
    v_lshlrev_b32 v60, 16, v60
    v_mul_f32 v60, v60, v35
    v_lshlrev_b32 v61, 16, v61
    v_mul_f32 v61, v61, v35
    v_lshlrev_b32 v62, 16, v62
    v_mul_f32 v62, v62, v35
    v_lshlrev_b32 v63, 16, v63
    v_mul_f32 v63, v63, v35
    v_cvt_pk_bf16_f32 v160, v48, v49
    v_cvt_pk_bf16_f32 v161, v50, v51
    v_cvt_pk_bf16_f32 v162, v52, v53
    v_cvt_pk_bf16_f32 v163, v54, v55
    v_cvt_pk_bf16_f32 v164, v56, v57
    v_cvt_pk_bf16_f32 v165, v58, v59
    v_cvt_pk_bf16_f32 v166, v60, v61
    v_cvt_pk_bf16_f32 v167, v62, v63
    s_cmp_lt_u32 s101, 4
    s_cbranch_scc1 S_XD1
    s_cmp_lg_u32 s7, 1
    s_cbranch_scc1 S_XD1
    s_mov_b32 s24, 8
    s_and_b32 s25, s101, 1
    s_and_b32 s26, s101, 2
    s_lshl_b32 s26, s26, 1
    s_add_u32 s24, s24, 9
    s_sub_u32 s24, s24, s74
    s_cmp_ge_u32 s24, 9
    s_cselect_b32 s27, 9, 0
    s_sub_u32 s24, s24, s27
    s_lshl_b32 s24, s24, 13
    s_lshl_b32 s25, s25, 12
    s_add_u32 s24, s24, s25
    s_add_u32 s24, s24, 82944
    v_bfe_u32 v16, v0, 3, 2
    v_add_u32 v16, s26, v16
    v_lshrrev_b32 v17, 5, v0
    v_lshlrev_b32 v18, 1, v17
    v_xor_b32 v16, v16, v18
    v_lshlrev_b32 v16, 4, v16
    v_lshl_add_u32 v16, v17, 9, v16
    v_and_b32 v17, 7, v0
    v_lshl_add_u32 v16, v17, 1, v16
    v_add_u32 v16, s24, v16
    v_xor_b32 v17, 16, v16
    v_xor_b32 v18, 64, v16
    v_xor_b32 v19, 0x50, v16
    ds_read_u16 v48, v16 offset:0
    ds_read_u16 v49, v16 offset:128
    ds_read_u16 v50, v17 offset:256
    ds_read_u16 v51, v17 offset:384
    ds_read_u16 v52, v18 offset:1024
    ds_read_u16 v53, v18 offset:1152
    ds_read_u16 v54, v19 offset:1280
    ds_read_u16 v55, v19 offset:1408
    s_waitcnt lgkmcnt(4)
    ds_read_u16 v56, v16 offset:2048
    ds_read_u16 v57, v16 offset:2176
    ds_read_u16 v58, v17 offset:2304
    ds_read_u16 v59, v17 offset:2432
    ds_read_u16 v60, v18 offset:3072
    ds_read_u16 v61, v18 offset:3200
    ds_read_u16 v62, v19 offset:3328
    ds_read_u16 v63, v19 offset:3456
    v_lshlrev_b32 v39, 16, v39
    s_waitcnt lgkmcnt(0)
    v_lshlrev_b32 v48, 16, v48
    v_mul_f32 v48, v48, v39
    v_lshlrev_b32 v49, 16, v49
    v_mul_f32 v49, v49, v39
    v_lshlrev_b32 v50, 16, v50
    v_mul_f32 v50, v50, v39
    v_lshlrev_b32 v51, 16, v51
    v_mul_f32 v51, v51, v39
    v_lshlrev_b32 v52, 16, v52
    v_mul_f32 v52, v52, v39
    v_lshlrev_b32 v53, 16, v53
    v_mul_f32 v53, v53, v39
    v_lshlrev_b32 v54, 16, v54
    v_mul_f32 v54, v54, v39
    v_lshlrev_b32 v55, 16, v55
    v_mul_f32 v55, v55, v39
    v_lshlrev_b32 v56, 16, v56
    v_mul_f32 v56, v56, v39
    v_lshlrev_b32 v57, 16, v57
    v_mul_f32 v57, v57, v39
    v_lshlrev_b32 v58, 16, v58
    v_mul_f32 v58, v58, v39
    v_lshlrev_b32 v59, 16, v59
    v_mul_f32 v59, v59, v39
    v_lshlrev_b32 v60, 16, v60
    v_mul_f32 v60, v60, v39
    v_lshlrev_b32 v61, 16, v61
    v_mul_f32 v61, v61, v39
    v_lshlrev_b32 v62, 16, v62
    v_mul_f32 v62, v62, v39
    v_lshlrev_b32 v63, 16, v63
    v_mul_f32 v63, v63, v39
    v_cvt_pk_bf16_f32 v152, v48, v49
    v_cvt_pk_bf16_f32 v153, v50, v51
    v_cvt_pk_bf16_f32 v154, v52, v53
    v_cvt_pk_bf16_f32 v155, v54, v55
    v_cvt_pk_bf16_f32 v156, v56, v57
    v_cvt_pk_bf16_f32 v157, v58, v59
    v_cvt_pk_bf16_f32 v158, v60, v61
    v_cvt_pk_bf16_f32 v159, v62, v63
S_XD1:
    s_setprio 3
SP_61:
    ds_read_b32 v4, v2 offset:116
    s_waitcnt lgkmcnt(0)
    v_readfirstlane_b32 s24, v4
    s_cmp_ge_u32 s24, 2
    s_cbranch_scc1 SD_62
    s_sleep 1
    s_sub_u32 s72, s72, 1
    s_cbranch_scc0 SP_61
    s_mov_b32 s72, 0
SD_62:
    s_mul_i32 s12, s2, 10923
    s_lshr_b32 s12, s12, 16
    s_mul_i32 s13, s12, 6
    s_sub_u32 s13, s2, s13
    s_and_b32 s14, s13, 1
    s_cselect_b32 s76, s44, s42
    s_cselect_b32 s77, s45, s43
    s_mov_b32 s78, 663552
    s_mov_b32 s79, 0x20000
    s_lshr_b32 s13, s13, 1
    s_mul_i32 s13, s13, 3
    s_add_u32 s13, s13, s7
    s_mul_i32 s15, s12, 18432
    s_lshl_b32 s24, s13, 7
    s_add_u32 s15, s15, s24
    s_cmp_eq_u32 s7, 3
    s_cselect_b32 s15, 0x100000, s15
    v_lshrrev_b32 v29, 4, v0
    v_mul_u32_u24 v30, 1152, v27
    v_lshl_add_u32 v30, v29, 4, v30
    buffer_load_dwordx4 v[64:67], v30, s[76:79], s15 offen
    buffer_load_dwordx4 v[68:71], v30, s[76:79], s15 offen offset:64
    v_lshlrev_b32 v30, 4, v27
    v_lshl_add_u32 v30, v29, 9, v30
    s_mul_i32 s12, s12, 36864
    s_lshl_b32 s13, s13, 12
    s_add_u32 s12, s12, s13
    s_lshl_b32 s14, s14, 8
    s_add_u32 s12, s12, s14
    s_add_u32 s12, s12, 688128
    s_cmp_ge_u32 s15, 663552
    s_cselect_b32 s12, 12582912, s12
    s_mov_b32 s15, s12
    s_waitcnt vmcnt(0)
    buffer_store_dwordx4 v[64:67], v30, s[32:35], s15 offen sc1
    buffer_store_dwordx4 v[68:71], v30, s[32:35], s15 offen offset:2048 sc1
    s_lshr_b32 s25, s2, 2
    s_lshl_b32 s25, s25, 7
    s_and_b32 s24, s2, 3
    s_lshl_b32 s24, s24, 2
    s_add_u32 s25, s25, s24
    s_add_u32 s25, s25, 12058624
    s_waitcnt vmcnt(0)
    s_mov_b64 exec, 1
    ds_add_rtn_u32 v4, v2, v3 offset:120
    s_waitcnt lgkmcnt(0)
    v_readfirstlane_b32 s24, v4
    s_mov_b64 exec, -1
    s_cmp_lg_u32 s24, 3
    s_cbranch_scc1 LF_63
    v_lshlrev_b32 v4, 13, v0
    v_mov_b32 v16, s73
    s_mov_b64 exec, 255
    buffer_store_dword v16, v4, s[32:35], s25 offen sc1
    s_mov_b64 exec, -1
LF_63:
    v_mov_b32 v40, 0
    v_mov_b32 v41, s73
    v_mov_b32 v42, 0
    v_mov_b32 v43, s73
    s_lshl_b32 s24, s8, 14
    s_lshl_b32 s26, s4, 8
    s_add_u32 s24, s24, s26
    s_add_u32 s24, s24, 4063232
    s_lshl_b32 s25, s11, 14
    s_lshl_b32 s26, s4, 8
    s_add_u32 s25, s25, s26
    s_add_u32 s25, s25, 4063232
    s_mov_b64 exec, 0xffff
    s_lshr_b32 s26, s100, 2
    s_or_b32 s26, s26, s7
    s_cselect_b32 s25, 12582912, s25
    buffer_store_dwordx4 v[40:43], v1, s[32:35], s24 offen sc1
    buffer_store_dwordx4 v[40:43], v1, s[32:35], s25 offen sc1
    s_mov_b64 exec, -1
    s_cmp_eq_u32 s31, 0
    s_cbranch_scc1 S_PL0
    v_and_b32 v48, 31, v0
    v_lshrrev_b32 v49, 5, v0
    s_cmp_eq_u32 s31, 2
    s_cbranch_scc1 S_PLW
    s_lshl_b32 s14, s30, 7
    s_lshl_b32 s28, s7, 5
    s_add_u32 s14, s14, s28
    v_mul_u32_u24 v50, 1152, v48
    v_lshl_add_u32 v50, v49, 4, v50
    s_mul_i32 s28, s29, 73728
    s_add_u32 s14, s14, s28
    s_add_u32 s28, s14, 36864
    s_mov_b32 s76, s46
    s_mov_b32 s77, s47
    s_mov_b32 s78, 663552
    s_mov_b32 s79, 0x20000
    buffer_load_dwordx4 v[96:99], v50, s[76:79], s14 offen
    buffer_load_dwordx4 v[104:107], v50, s[76:79], s28 offen
    s_mov_b32 s76, s48
    s_mov_b32 s77, s49
    s_mov_b32 s78, 663552
    s_mov_b32 s79, 0x20000
    buffer_load_dwordx4 v[100:103], v50, s[76:79], s14 offen
    buffer_load_dwordx4 v[108:111], v50, s[76:79], s28 offen
    s_branch S_PL0
S_PLW:
    s_mov_b32 s76, s62
    s_mov_b32 s77, s63
    s_mov_b32 s78, 663552
    s_mov_b32 s79, 0x20000
    s_lshl_b32 s14, s29, 7
    s_cmp_ge_u32 s30, 16
    s_cbranch_scc1 S_PLX
    v_mul_u32_u24 v50, 4608, v49
    v_lshl_add_u32 v50, v48, 2, v50
    s_mul_i32 s28, s30, 41472
    s_add_u32 s14, s14, s28
    buffer_load_dword v96, v50, s[76:79], s14 offen offset:0
    buffer_load_dword v97, v50, s[76:79], s14 offen offset:1152
    buffer_load_dword v98, v50, s[76:79], s14 offen offset:2304
    buffer_load_dword v99, v50, s[76:79], s14 offen offset:3456
    s_add_u32 s14, s14, 9216
    buffer_load_dword v100, v50, s[76:79], s14 offen offset:0
    buffer_load_dword v101, v50, s[76:79], s14 offen offset:1152
    buffer_load_dword v102, v50, s[76:79], s14 offen offset:2304
    buffer_load_dword v103, v50, s[76:79], s14 offen offset:3456
    s_add_u32 s14, s14, 11520
    buffer_load_dword v104, v50, s[76:79], s14 offen offset:0
    buffer_load_dword v105, v50, s[76:79], s14 offen offset:1152
    buffer_load_dword v106, v50, s[76:79], s14 offen offset:2304
    buffer_load_dword v107, v50, s[76:79], s14 offen offset:3456
    s_add_u32 s14, s14, 9216
    buffer_load_dword v108, v50, s[76:79], s14 offen offset:0
    buffer_load_dword v109, v50, s[76:79], s14 offen offset:1152
    buffer_load_dword v110, v50, s[76:79], s14 offen offset:2304
    buffer_load_dword v111, v50, s[76:79], s14 offen offset:3456
    s_add_u32 s14, s14, 11520
    s_branch S_PL0
S_PLX:
    v_mul_u32_u24 v50, 82944, v49
    v_lshl_add_u32 v50, v48, 2, v50
    s_sub_u32 s28, s30, 16
    s_mul_i32 s28, s28, 331776
    s_add_u32 s14, s14, s28
    s_add_u32 s14, s14, 18432
    buffer_load_dword v96, v50, s[76:79], s14 offen offset:0
    buffer_load_dword v97, v50, s[76:79], s14 offen offset:1152
    s_add_u32 s14, s14, 20736
    buffer_load_dword v98, v50, s[76:79], s14 offen offset:0
    buffer_load_dword v99, v50, s[76:79], s14 offen offset:1152
    s_add_u32 s14, s14, 20736
    buffer_load_dword v100, v50, s[76:79], s14 offen offset:0
    buffer_load_dword v101, v50, s[76:79], s14 offen offset:1152
    s_add_u32 s14, s14, 20736
    buffer_load_dword v102, v50, s[76:79], s14 offen offset:0
    buffer_load_dword v103, v50, s[76:79], s14 offen offset:1152
    s_add_u32 s14, s14, 103680
    buffer_load_dword v104, v50, s[76:79], s14 offen offset:0
    buffer_load_dword v105, v50, s[76:79], s14 offen offset:1152
    s_add_u32 s14, s14, 20736
    buffer_load_dword v106, v50, s[76:79], s14 offen offset:0
    buffer_load_dword v107, v50, s[76:79], s14 offen offset:1152
    s_add_u32 s14, s14, 20736
    buffer_load_dword v108, v50, s[76:79], s14 offen offset:0
    buffer_load_dword v109, v50, s[76:79], s14 offen offset:1152
    s_add_u32 s14, s14, 20736
    buffer_load_dword v110, v50, s[76:79], s14 offen offset:0
    buffer_load_dword v111, v50, s[76:79], s14 offen offset:1152
    s_add_u32 s14, s14, 103680
S_PL0:
    s_cmp_eq_u32 s31, 0
    s_cbranch_scc1 S_PC0
    s_waitcnt vmcnt(0)
    v_lshrrev_b32 v46, 5, v0
    s_cmp_eq_u32 s31, 2
    s_cbranch_scc1 S_PCW
    v_lshl_add_u32 v47, v46, 6, s3
    ds_read_b128 v[64:67], v47 offset:0
    ds_read_b128 v[68:71], v47 offset:16
    ds_read_b128 v[72:75], v47 offset:32
    ds_read_b128 v[76:79], v47 offset:48
    s_mul_i32 s14, s29, 147456
    s_lshl_b32 s28, s30, 13
    s_add_u32 s14, s14, s28
    s_lshl_b32 s28, s7, 11
    s_add_u32 s14, s14, s28
    s_add_u32 s14, s14, 2015232
    s_waitcnt lgkmcnt(0)
    v_lshlrev_b32 v48, 16, v96
    v_lshlrev_b32 v49, 16, v100
    v_mul_f32 v50, v49, v65
    v_mul_f32 v51, v49, v64
    v_fma_f32 v50, v48, v64, -v50
    v_fma_f32 v51, -v48, v65, -v51
    v_cvt_pk_bf16_f32 v80, v50, v51
    v_and_b32 v48, 0xffff0000, v96
    v_and_b32 v49, 0xffff0000, v100
    v_mul_f32 v50, v49, v67
    v_mul_f32 v51, v49, v66
    v_fma_f32 v50, v48, v66, -v50
    v_fma_f32 v51, -v48, v67, -v51
    v_cvt_pk_bf16_f32 v81, v50, v51
    v_lshlrev_b32 v48, 16, v97
    v_lshlrev_b32 v49, 16, v101
    v_mul_f32 v50, v49, v69
    v_mul_f32 v51, v49, v68
    v_fma_f32 v50, v48, v68, -v50
    v_fma_f32 v51, -v48, v69, -v51
    v_cvt_pk_bf16_f32 v82, v50, v51
    v_and_b32 v48, 0xffff0000, v97
    v_and_b32 v49, 0xffff0000, v101
    v_mul_f32 v50, v49, v71
    v_mul_f32 v51, v49, v70
    v_fma_f32 v50, v48, v70, -v50
    v_fma_f32 v51, -v48, v71, -v51
    v_cvt_pk_bf16_f32 v83, v50, v51
    v_lshlrev_b32 v48, 16, v98
    v_lshlrev_b32 v49, 16, v102
    v_mul_f32 v50, v49, v73
    v_mul_f32 v51, v49, v72
    v_fma_f32 v50, v48, v72, -v50
    v_fma_f32 v51, -v48, v73, -v51
    v_cvt_pk_bf16_f32 v84, v50, v51
    v_and_b32 v48, 0xffff0000, v98
    v_and_b32 v49, 0xffff0000, v102
    v_mul_f32 v50, v49, v75
    v_mul_f32 v51, v49, v74
    v_fma_f32 v50, v48, v74, -v50
    v_fma_f32 v51, -v48, v75, -v51
    v_cvt_pk_bf16_f32 v85, v50, v51
    v_lshlrev_b32 v48, 16, v99
    v_lshlrev_b32 v49, 16, v103
    v_mul_f32 v50, v49, v77
    v_mul_f32 v51, v49, v76
    v_fma_f32 v50, v48, v76, -v50
    v_fma_f32 v51, -v48, v77, -v51
    v_cvt_pk_bf16_f32 v86, v50, v51
    v_and_b32 v48, 0xffff0000, v99
    v_and_b32 v49, 0xffff0000, v103
    v_mul_f32 v50, v49, v79
    v_mul_f32 v51, v49, v78
    v_fma_f32 v50, v48, v78, -v50
    v_fma_f32 v51, -v48, v79, -v51
    v_cvt_pk_bf16_f32 v87, v50, v51
    v_lshlrev_b32 v48, 16, v104
    v_lshlrev_b32 v49, 16, v108
    v_mul_f32 v50, v49, v65
    v_mul_f32 v51, v49, v64
    v_fma_f32 v50, v48, v64, -v50
    v_fma_f32 v51, -v48, v65, -v51
    v_cvt_pk_bf16_f32 v88, v50, v51
    v_and_b32 v48, 0xffff0000, v104
    v_and_b32 v49, 0xffff0000, v108
    v_mul_f32 v50, v49, v67
    v_mul_f32 v51, v49, v66
    v_fma_f32 v50, v48, v66, -v50
    v_fma_f32 v51, -v48, v67, -v51
    v_cvt_pk_bf16_f32 v89, v50, v51
    v_lshlrev_b32 v48, 16, v105
    v_lshlrev_b32 v49, 16, v109
    v_mul_f32 v50, v49, v69
    v_mul_f32 v51, v49, v68
    v_fma_f32 v50, v48, v68, -v50
    v_fma_f32 v51, -v48, v69, -v51
    v_cvt_pk_bf16_f32 v90, v50, v51
    v_and_b32 v48, 0xffff0000, v105
    v_and_b32 v49, 0xffff0000, v109
    v_mul_f32 v50, v49, v71
    v_mul_f32 v51, v49, v70
    v_fma_f32 v50, v48, v70, -v50
    v_fma_f32 v51, -v48, v71, -v51
    v_cvt_pk_bf16_f32 v91, v50, v51
    v_lshlrev_b32 v48, 16, v106
    v_lshlrev_b32 v49, 16, v110
    v_mul_f32 v50, v49, v73
    v_mul_f32 v51, v49, v72
    v_fma_f32 v50, v48, v72, -v50
    v_fma_f32 v51, -v48, v73, -v51
    v_cvt_pk_bf16_f32 v92, v50, v51
    v_and_b32 v48, 0xffff0000, v106
    v_and_b32 v49, 0xffff0000, v110
    v_mul_f32 v50, v49, v75
    v_mul_f32 v51, v49, v74
    v_fma_f32 v50, v48, v74, -v50
    v_fma_f32 v51, -v48, v75, -v51
    v_cvt_pk_bf16_f32 v93, v50, v51
    v_lshlrev_b32 v48, 16, v107
    v_lshlrev_b32 v49, 16, v111
    v_mul_f32 v50, v49, v77
    v_mul_f32 v51, v49, v76
    v_fma_f32 v50, v48, v76, -v50
    v_fma_f32 v51, -v48, v77, -v51
    v_cvt_pk_bf16_f32 v94, v50, v51
    v_and_b32 v48, 0xffff0000, v107
    v_and_b32 v49, 0xffff0000, v111
    v_mul_f32 v50, v49, v79
    v_mul_f32 v51, v49, v78
    v_fma_f32 v50, v48, v78, -v50
    v_fma_f32 v51, -v48, v79, -v51
    v_cvt_pk_bf16_f32 v95, v50, v51
    s_add_u32 s12, s14, 512
    s_mov_b32 s13, 73728
    s_branch S_PC0
S_PCW:
    s_mul_i32 s14, s29, 73728
    s_lshl_b32 s28, s30, 11
    s_add_u32 s14, s14, s28
    s_add_u32 s14, s14, 3342336
    s_mov_b32 s12, 0x05040100
    s_mov_b32 s13, 0x07060302
    v_perm_b32 v80, v97, v96, s12
    v_perm_b32 v84, v97, v96, s13
    v_perm_b32 v81, v99, v98, s12
    v_perm_b32 v85, v99, v98, s13
    v_perm_b32 v82, v101, v100, s12
    v_perm_b32 v86, v101, v100, s13
    v_perm_b32 v83, v103, v102, s12
    v_perm_b32 v87, v103, v102, s13
    v_perm_b32 v88, v105, v104, s12
    v_perm_b32 v92, v105, v104, s13
    v_perm_b32 v89, v107, v106, s12
    v_perm_b32 v93, v107, v106, s13
    v_perm_b32 v90, v109, v108, s12
    v_perm_b32 v94, v109, v108, s13
    v_perm_b32 v91, v111, v110, s12
    v_perm_b32 v95, v111, v110, s13
    s_add_u32 s12, s14, 16
    s_movk_i32 s13, 0x400
S_PC0:
SP_64:
    ds_read_b32 v4, v2 offset:0
    s_waitcnt lgkmcnt(0)
    v_readfirstlane_b32 s24, v4
    s_cmp_ge_u32 s24, 8
    s_cbranch_scc1 SD_65
    s_sleep 1
    s_sub_u32 s72, s72, 1
    s_cbranch_scc0 SP_64
    s_mov_b32 s72, 0
SD_65:
    s_cmp_lg_u32 s7, 3
    s_cbranch_scc1 S_NOBP
    s_mul_i32 s24, s5, 768
    v_lshl_add_u32 v16, v0, 7, s24
    s_mov_b64 exec, 0xc0
    s_mul_i32 s24, s100, 3
    s_lshr_b32 s24, s24, 1
    s_add_u32 s24, s24, 42
    s_lshl_b32 s24, s24, 7
    v_lshl_add_u32 v16, v0, 7, s24
    s_cmp_lt_u32 s100, 4
    s_cselect_b32 exec_lo, 0xff, 63
    s_and_b32 s18, s2, 7
    s_lshl_b32 s18, s18, 13
    s_add_u32 s18, s18, 12058624
PL_66:
    buffer_load_dwordx4 v[20:23], v16, s[32:35], s18 offen sc1
    s_waitcnt vmcnt(0)
    v_xor_b32 v4, s73, v20
    v_bitop3_b32 v4, v4, v21, s73 bitop3:0xf6
    v_bitop3_b32 v4, v4, v22, s73 bitop3:0xf6
    v_bitop3_b32 v4, v4, v23, s73 bitop3:0xf6
    v_cmp_ne_u32 vcc, 0, v4
    s_cbranch_vccz PD_67
    s_mov_b64 exec, vcc
    s_sleep 4
    s_sub_u32 s72, s72, 1
    s_cbranch_scc0 PL_66
    s_mov_b32 s72, 0
PD_67:
    s_mov_b64 exec, 1
    ds_add_u32 v2, v3 offset:124
    s_mov_b64 exec, -1
S_NOBP:
SP_68:
    ds_read_b32 v4, v2 offset:124
    s_waitcnt lgkmcnt(0)
    v_readfirstlane_b32 s24, v4
    s_cmp_ge_u32 s24, 1
    s_cbranch_scc1 SD_69
    s_sleep 1
    s_sub_u32 s72, s72, 1
    s_cbranch_scc0 SP_68
    s_mov_b32 s72, 0
SD_69:
    s_add_u32 s18, s16, s17
    buffer_load_dwordx4 v[96:99], v1, s[32:35], s18 offen offset:0 sc1
    buffer_load_dwordx4 v[100:103], v1, s[32:35], s18 offen offset:1024 sc1
    buffer_load_dwordx4 v[104:107], v1, s[32:35], s18 offen offset:2048 sc1
    buffer_load_dwordx4 v[108:111], v1, s[32:35], s18 offen offset:3072 sc1
    s_add_u32 s17, s17, 4096
    s_cmp_eq_u32 s17, 36864
    s_cselect_b32 s17, 0, s17
    s_add_u32 s18, s16, s17
    buffer_load_dwordx4 v[112:115], v1, s[32:35], s18 offen offset:0 sc1
    buffer_load_dwordx4 v[116:119], v1, s[32:35], s18 offen offset:1024 sc1
    buffer_load_dwordx4 v[120:123], v1, s[32:35], s18 offen offset:2048 sc1
    buffer_load_dwordx4 v[124:127], v1, s[32:35], s18 offen offset:3072 sc1
    s_add_u32 s17, s17, 4096
    s_cmp_eq_u32 s17, 36864
    s_cselect_b32 s17, 0, s17
    s_add_u32 s18, s16, s17
    buffer_load_dwordx4 v[128:131], v1, s[32:35], s18 offen offset:0 sc1
    buffer_load_dwordx4 v[132:135], v1, s[32:35], s18 offen offset:1024 sc1
    buffer_load_dwordx4 v[136:139], v1, s[32:35], s18 offen offset:2048 sc1
    buffer_load_dwordx4 v[140:143], v1, s[32:35], s18 offen offset:3072 sc1
    s_add_u32 s17, s17, 4096
    s_cmp_eq_u32 s17, 36864
    s_cselect_b32 s17, 0, s17
    s_setprio 3
    ds_read_b128 v[48:51], v8 offset:0
    ds_read_b128 v[52:55], v8 offset:4096
    ds_read_b128 v[56:59], v9 offset:0
    ds_read_b128 v[60:63], v9 offset:4096
    ds_read_b128 v[64:67], v10 offset:0
    ds_read_b128 v[68:71], v10 offset:4096
    ds_read_b128 v[72:75], v11 offset:0
    ds_read_b128 v[76:79], v11 offset:4096
    s_waitcnt vmcnt(11) lgkmcnt(6)
    v_mfma_f32_32x32x16_bf16 v[16:31], v[48:51], v[96:99], 0
    v_mfma_f32_32x32x16_bf16 v[32:47], v[52:55], v[96:99], 0
    s_add_u32 s18, s16, s17
    buffer_load_dwordx4 v[96:99], v1, s[32:35], s18 offen offset:0 sc1
    ds_read_b128 v[48:51], v8 offset:8192
    ds_read_b128 v[52:55], v8 offset:12288
    s_waitcnt vmcnt(11) lgkmcnt(6)
    v_mfma_f32_32x32x16_bf16 v[16:31], v[56:59], v[100:103], v[16:31]
    v_mfma_f32_32x32x16_bf16 v[32:47], v[60:63], v[100:103], v[32:47]
    buffer_load_dwordx4 v[100:103], v1, s[32:35], s18 offen offset:1024 sc1
    ds_read_b128 v[56:59], v9 offset:8192
    ds_read_b128 v[60:63], v9 offset:12288
    s_waitcnt vmcnt(11) lgkmcnt(6)
    v_mfma_f32_32x32x16_bf16 v[16:31], v[64:67], v[104:107], v[16:31]
    v_mfma_f32_32x32x16_bf16 v[32:47], v[68:71], v[104:107], v[32:47]
    buffer_load_dwordx4 v[104:107], v1, s[32:35], s18 offen offset:2048 sc1
    ds_read_b128 v[64:67], v10 offset:8192
    ds_read_b128 v[68:71], v10 offset:12288
    s_waitcnt vmcnt(11) lgkmcnt(6)
    v_mfma_f32_32x32x16_bf16 v[16:31], v[72:75], v[108:111], v[16:31]
    v_mfma_f32_32x32x16_bf16 v[32:47], v[76:79], v[108:111], v[32:47]
    buffer_load_dwordx4 v[108:111], v1, s[32:35], s18 offen offset:3072 sc1
    s_add_u32 s17, s17, 4096
    s_cmp_eq_u32 s17, 36864
    s_cselect_b32 s17, 0, s17
    ds_read_b128 v[72:75], v11 offset:8192
    ds_read_b128 v[76:79], v11 offset:12288
    s_waitcnt vmcnt(11) lgkmcnt(6)
    v_mfma_f32_32x32x16_bf16 v[16:31], v[48:51], v[112:115], v[16:31]
    v_mfma_f32_32x32x16_bf16 v[32:47], v[52:55], v[112:115], v[32:47]
    s_add_u32 s18, s16, s17
    buffer_load_dwordx4 v[112:115], v1, s[32:35], s18 offen offset:0 sc1
    ds_read_b128 v[48:51], v8 offset:16384
    ds_read_b128 v[52:55], v8 offset:20480
    s_waitcnt vmcnt(11) lgkmcnt(6)
    v_mfma_f32_32x32x16_bf16 v[16:31], v[56:59], v[116:119], v[16:31]
    v_mfma_f32_32x32x16_bf16 v[32:47], v[60:63], v[116:119], v[32:47]
    buffer_load_dwordx4 v[116:119], v1, s[32:35], s18 offen offset:1024 sc1
    ds_read_b128 v[56:59], v9 offset:16384
    ds_read_b128 v[60:63], v9 offset:20480
    s_waitcnt vmcnt(11) lgkmcnt(6)
    v_mfma_f32_32x32x16_bf16 v[16:31], v[64:67], v[120:123], v[16:31]
    v_mfma_f32_32x32x16_bf16 v[32:47], v[68:71], v[120:123], v[32:47]
    buffer_load_dwordx4 v[120:123], v1, s[32:35], s18 offen offset:2048 sc1
    ds_read_b128 v[64:67], v10 offset:16384
    ds_read_b128 v[68:71], v10 offset:20480
    s_waitcnt vmcnt(11) lgkmcnt(6)
    v_mfma_f32_32x32x16_bf16 v[16:31], v[72:75], v[124:127], v[16:31]
    v_mfma_f32_32x32x16_bf16 v[32:47], v[76:79], v[124:127], v[32:47]
    buffer_load_dwordx4 v[124:127], v1, s[32:35], s18 offen offset:3072 sc1
    s_add_u32 s17, s17, 4096
    s_cmp_eq_u32 s17, 36864
    s_cselect_b32 s17, 0, s17
    ds_read_b128 v[72:75], v11 offset:16384
    ds_read_b128 v[76:79], v11 offset:20480
    s_waitcnt vmcnt(11) lgkmcnt(6)
    v_mfma_f32_32x32x16_bf16 v[16:31], v[48:51], v[128:131], v[16:31]
    v_mfma_f32_32x32x16_bf16 v[32:47], v[52:55], v[128:131], v[32:47]
    s_add_u32 s18, s16, s17
    buffer_load_dwordx4 v[128:131], v1, s[32:35], s18 offen offset:0 sc1
SP_70:
    ds_read_b32 v4, v2 offset:8
    s_waitcnt lgkmcnt(0)
    v_readfirstlane_b32 s24, v4
    s_and_b32 s24, s24, 0xff
    s_cmp_ge_u32 s24, 8
    s_cbranch_scc1 SD_71
    s_sleep 2
    s_sub_u32 s72, s72, 1
    s_cbranch_scc0 SP_70
    s_mov_b32 s72, 0
SD_71:
    s_lshl_b32 s24, s7, 10
    s_add_u32 s25, s24, 602112
    s_add_u32 m0, s24, 0
    s_nop 0
    buffer_load_dwordx4 v1, s[32:35], s25 offen sc1 lds
    s_add_u32 s25, s25, 4096
    s_add_u32 m0, s24, 4096
    s_nop 0
    buffer_load_dwordx4 v1, s[32:35], s25 offen sc1 lds
    s_add_u32 s25, s25, 4096
    s_add_u32 m0, s24, 8192
    s_nop 0
    buffer_load_dwordx4 v1, s[32:35], s25 offen sc1 lds
    s_add_u32 s25, s25, 4096
    s_add_u32 m0, s24, 12288
    s_nop 0
    buffer_load_dwordx4 v1, s[32:35], s25 offen sc1 lds
    s_add_u32 s25, s25, 4096
    s_cmp_eq_u32 s7, 3
    s_cbranch_scc1 S_RF
    s_add_u32 m0, s24, 16384
    s_nop 0
    buffer_load_dwordx4 v1, s[32:35], s25 offen sc1 lds
    s_add_u32 s25, s25, 4096
S_RF:
    ds_read_b128 v[48:51], v8 offset:24576
    ds_read_b128 v[52:55], v8 offset:28672
    s_waitcnt vmcnt(11) lgkmcnt(6)
    v_mfma_f32_32x32x16_bf16 v[16:31], v[56:59], v[132:135], v[16:31]
    v_mfma_f32_32x32x16_bf16 v[32:47], v[60:63], v[132:135], v[32:47]
    buffer_load_dwordx4 v[132:135], v1, s[32:35], s18 offen offset:1024 sc1
    ds_read_b128 v[56:59], v9 offset:24576
    ds_read_b128 v[60:63], v9 offset:28672
    s_waitcnt vmcnt(11) lgkmcnt(6)
    v_mfma_f32_32x32x16_bf16 v[16:31], v[64:67], v[136:139], v[16:31]
    v_mfma_f32_32x32x16_bf16 v[32:47], v[68:71], v[136:139], v[32:47]
    buffer_load_dwordx4 v[136:139], v1, s[32:35], s18 offen offset:2048 sc1
    ds_read_b128 v[64:67], v10 offset:24576
    ds_read_b128 v[68:71], v10 offset:28672
    s_waitcnt vmcnt(11) lgkmcnt(6)
    v_mfma_f32_32x32x16_bf16 v[16:31], v[72:75], v[140:143], v[16:31]
    v_mfma_f32_32x32x16_bf16 v[32:47], v[76:79], v[140:143], v[32:47]
    buffer_load_dwordx4 v[140:143], v1, s[32:35], s18 offen offset:3072 sc1
    s_add_u32 s17, s17, 4096
    s_cmp_eq_u32 s17, 36864
    s_cselect_b32 s17, 0, s17
    ds_read_b128 v[72:75], v11 offset:24576
    ds_read_b128 v[76:79], v11 offset:28672
    s_waitcnt vmcnt(11) lgkmcnt(6)
    v_mfma_f32_32x32x16_bf16 v[16:31], v[48:51], v[96:99], v[16:31]
    v_mfma_f32_32x32x16_bf16 v[32:47], v[52:55], v[96:99], v[32:47]
    s_add_u32 s18, s16, s17
    buffer_load_dwordx4 v[96:99], v1, s[32:35], s18 offen offset:0 sc1
    v_add_u32 v8, 32768, v8
    v_add_u32 v9, 32768, v9
    v_add_u32 v10, 32768, v10
    v_add_u32 v11, 32768, v11
    ds_read_b128 v[48:51], v8 offset:0
    ds_read_b128 v[52:55], v8 offset:4096
    s_waitcnt vmcnt(11) lgkmcnt(6)
    v_mfma_f32_32x32x16_bf16 v[16:31], v[56:59], v[100:103], v[16:31]
    v_mfma_f32_32x32x16_bf16 v[32:47], v[60:63], v[100:103], v[32:47]
    buffer_load_dwordx4 v[100:103], v1, s[32:35], s18 offen offset:1024 sc1
    ds_read_b128 v[56:59], v9 offset:0
    ds_read_b128 v[60:63], v9 offset:4096
    s_waitcnt vmcnt(11) lgkmcnt(6)
    v_mfma_f32_32x32x16_bf16 v[16:31], v[64:67], v[104:107], v[16:31]
    v_mfma_f32_32x32x16_bf16 v[32:47], v[68:71], v[104:107], v[32:47]
    buffer_load_dwordx4 v[104:107], v1, s[32:35], s18 offen offset:2048 sc1
    ds_read_b128 v[64:67], v10 offset:0
    ds_read_b128 v[68:71], v10 offset:4096
    s_waitcnt vmcnt(11) lgkmcnt(6)
    v_mfma_f32_32x32x16_bf16 v[16:31], v[72:75], v[108:111], v[16:31]
    v_mfma_f32_32x32x16_bf16 v[32:47], v[76:79], v[108:111], v[32:47]
    buffer_load_dwordx4 v[108:111], v1, s[32:35], s18 offen offset:3072 sc1
    s_add_u32 s17, s17, 4096
    s_cmp_eq_u32 s17, 36864
    s_cselect_b32 s17, 0, s17
    ds_read_b128 v[72:75], v11 offset:0
    ds_read_b128 v[76:79], v11 offset:4096
    s_waitcnt vmcnt(11) lgkmcnt(6)
    v_mfma_f32_32x32x16_bf16 v[16:31], v[48:51], v[112:115], v[16:31]
    v_mfma_f32_32x32x16_bf16 v[32:47], v[52:55], v[112:115], v[32:47]
    s_add_u32 s18, s16, s17
    buffer_load_dwordx4 v[112:115], v1, s[32:35], s18 offen offset:0 sc1
    ds_read_b128 v[48:51], v8 offset:8192
    ds_read_b128 v[52:55], v8 offset:12288
    s_waitcnt vmcnt(11) lgkmcnt(6)
    v_mfma_f32_32x32x16_bf16 v[16:31], v[56:59], v[116:119], v[16:31]
    v_mfma_f32_32x32x16_bf16 v[32:47], v[60:63], v[116:119], v[32:47]
    buffer_load_dwordx4 v[116:119], v1, s[32:35], s18 offen offset:1024 sc1
    ds_read_b128 v[56:59], v9 offset:8192
    ds_read_b128 v[60:63], v9 offset:12288
    s_waitcnt vmcnt(11) lgkmcnt(6)
    v_mfma_f32_32x32x16_bf16 v[16:31], v[64:67], v[120:123], v[16:31]
    v_mfma_f32_32x32x16_bf16 v[32:47], v[68:71], v[120:123], v[32:47]
    buffer_load_dwordx4 v[120:123], v1, s[32:35], s18 offen offset:2048 sc1
    ds_read_b128 v[64:67], v10 offset:8192
    ds_read_b128 v[68:71], v10 offset:12288
    s_waitcnt vmcnt(11) lgkmcnt(6)
    v_mfma_f32_32x32x16_bf16 v[16:31], v[72:75], v[124:127], v[16:31]
    v_mfma_f32_32x32x16_bf16 v[32:47], v[76:79], v[124:127], v[32:47]
    buffer_load_dwordx4 v[124:127], v1, s[32:35], s18 offen offset:3072 sc1
    s_add_u32 s17, s17, 4096
    s_cmp_eq_u32 s17, 36864
    s_cselect_b32 s17, 0, s17
    ds_read_b128 v[72:75], v11 offset:8192
    ds_read_b128 v[76:79], v11 offset:12288
    s_waitcnt vmcnt(11) lgkmcnt(6)
    v_mfma_f32_32x32x16_bf16 v[16:31], v[48:51], v[128:131], v[16:31]
    v_mfma_f32_32x32x16_bf16 v[32:47], v[52:55], v[128:131], v[32:47]
    s_add_u32 s18, s16, s17
    buffer_load_dwordx4 v[128:131], v1, s[32:35], s18 offen offset:0 sc1
    ds_read_b128 v[48:51], v8 offset:16384
    ds_read_b128 v[52:55], v8 offset:20480
    s_waitcnt vmcnt(11) lgkmcnt(6)
    v_mfma_f32_32x32x16_bf16 v[16:31], v[56:59], v[132:135], v[16:31]
    v_mfma_f32_32x32x16_bf16 v[32:47], v[60:63], v[132:135], v[32:47]
    buffer_load_dwordx4 v[132:135], v1, s[32:35], s18 offen offset:1024 sc1
    s_mov_b64 exec, 1
    v_mov_b32 v4, 0x4000
    ds_add_u32 v2, v4 offset:16
    s_mov_b64 exec, -1
    ds_read_b128 v[56:59], v9 offset:16384
    ds_read_b128 v[60:63], v9 offset:20480
    s_waitcnt vmcnt(11) lgkmcnt(6)
    v_mfma_f32_32x32x16_bf16 v[16:31], v[64:67], v[136:139], v[16:31]
    v_mfma_f32_32x32x16_bf16 v[32:47], v[68:71], v[136:139], v[32:47]
    buffer_load_dwordx4 v[136:139], v1, s[32:35], s18 offen offset:2048 sc1
    ds_read_b128 v[64:67], v10 offset:16384
    ds_read_b128 v[68:71], v10 offset:20480
    s_waitcnt vmcnt(11) lgkmcnt(6)
    v_mfma_f32_32x32x16_bf16 v[16:31], v[72:75], v[140:143], v[16:31]
    v_mfma_f32_32x32x16_bf16 v[32:47], v[76:79], v[140:143], v[32:47]
    buffer_load_dwordx4 v[140:143], v1, s[32:35], s18 offen offset:3072 sc1
    s_add_u32 s17, s17, 4096
    s_cmp_eq_u32 s17, 36864
    s_cselect_b32 s17, 0, s17
    ds_read_b128 v[72:75], v11 offset:16384
    ds_read_b128 v[76:79], v11 offset:20480
    s_waitcnt vmcnt(11) lgkmcnt(6)
    v_mfma_f32_32x32x16_bf16 v[16:31], v[48:51], v[96:99], v[16:31]
    v_mfma_f32_32x32x16_bf16 v[32:47], v[52:55], v[96:99], v[32:47]
    s_add_u32 s18, s19, s20
    buffer_load_dwordx4 v[96:99], v1, s[32:35], s18 offen sc1
    s_add_u32 s20, s20, 1024
    s_cmp_eq_u32 s20, 36864
    s_cselect_b32 s20, 0, s20
    ds_read_b128 v[48:51], v8 offset:24576
    ds_read_b128 v[52:55], v8 offset:28672
    s_waitcnt vmcnt(11) lgkmcnt(6)
    v_mfma_f32_32x32x16_bf16 v[16:31], v[56:59], v[100:103], v[16:31]
    v_mfma_f32_32x32x16_bf16 v[32:47], v[60:63], v[100:103], v[32:47]
    s_add_u32 s18, s19, s20
    buffer_load_dwordx4 v[100:103], v1, s[32:35], s18 offen sc1
    s_add_u32 s20, s20, 1024
    s_cmp_eq_u32 s20, 36864
    s_cselect_b32 s20, 0, s20
    ds_read_b128 v[56:59], v9 offset:24576
    ds_read_b128 v[60:63], v9 offset:28672
    s_waitcnt vmcnt(11) lgkmcnt(6)
    v_mfma_f32_32x32x16_bf16 v[16:31], v[64:67], v[104:107], v[16:31]
    v_mfma_f32_32x32x16_bf16 v[32:47], v[68:71], v[104:107], v[32:47]
    s_add_u32 s18, s19, s20
    buffer_load_dwordx4 v[104:107], v1, s[32:35], s18 offen sc1
    s_add_u32 s20, s20, 1024
    s_cmp_eq_u32 s20, 36864
    s_cselect_b32 s20, 0, s20
    ds_read_b128 v[64:67], v10 offset:24576
    ds_read_b128 v[68:71], v10 offset:28672
    s_waitcnt vmcnt(11) lgkmcnt(6)
    v_mfma_f32_32x32x16_bf16 v[16:31], v[72:75], v[108:111], v[16:31]
    v_mfma_f32_32x32x16_bf16 v[32:47], v[76:79], v[108:111], v[32:47]
    s_add_u32 s18, s19, s20
    buffer_load_dwordx4 v[108:111], v1, s[32:35], s18 offen sc1
    s_add_u32 s20, s20, 1024
    s_cmp_eq_u32 s20, 36864
    s_cselect_b32 s20, 0, s20
    ds_read_b128 v[72:75], v11 offset:24576
    ds_read_b128 v[76:79], v11 offset:28672
    s_waitcnt vmcnt(11) lgkmcnt(6)
    v_mfma_f32_32x32x16_bf16 v[16:31], v[48:51], v[112:115], v[16:31]
    v_mfma_f32_32x32x16_bf16 v[32:47], v[52:55], v[112:115], v[32:47]
    s_add_u32 s18, s19, s20
    buffer_load_dwordx4 v[112:115], v1, s[32:35], s18 offen sc1
    s_add_u32 s20, s20, 1024
    s_cmp_eq_u32 s20, 36864
    s_cselect_b32 s20, 0, s20
    ds_read_b128 v[48:51], v8 offset:32768
    ds_read_b128 v[52:55], v8 offset:36864
    s_waitcnt vmcnt(11) lgkmcnt(6)
    v_mfma_f32_32x32x16_bf16 v[16:31], v[56:59], v[116:119], v[16:31]
    v_mfma_f32_32x32x16_bf16 v[32:47], v[60:63], v[116:119], v[32:47]
    s_add_u32 s18, s19, s20
    buffer_load_dwordx4 v[116:119], v1, s[32:35], s18 offen sc1
    s_add_u32 s20, s20, 1024
    s_cmp_eq_u32 s20, 36864
    s_cselect_b32 s20, 0, s20
    ds_read_b128 v[56:59], v9 offset:32768
    ds_read_b128 v[60:63], v9 offset:36864
    s_waitcnt vmcnt(11) lgkmcnt(6)
    v_mfma_f32_32x32x16_bf16 v[16:31], v[64:67], v[120:123], v[16:31]
    v_mfma_f32_32x32x16_bf16 v[32:47], v[68:71], v[120:123], v[32:47]
    s_add_u32 s18, s19, s20
    buffer_load_dwordx4 v[120:123], v1, s[32:35], s18 offen sc1
    s_add_u32 s20, s20, 1024
    s_cmp_eq_u32 s20, 36864
    s_cselect_b32 s20, 0, s20
    ds_read_b128 v[64:67], v10 offset:32768
    ds_read_b128 v[68:71], v10 offset:36864
    s_waitcnt vmcnt(11) lgkmcnt(6)
    v_mfma_f32_32x32x16_bf16 v[16:31], v[72:75], v[124:127], v[16:31]
    v_mfma_f32_32x32x16_bf16 v[32:47], v[76:79], v[124:127], v[32:47]
    s_add_u32 s18, s19, s20
    buffer_load_dwordx4 v[124:127], v1, s[32:35], s18 offen sc1
    s_add_u32 s20, s20, 1024
    s_cmp_eq_u32 s20, 36864
    s_cselect_b32 s20, 0, s20
    ds_read_b128 v[72:75], v11 offset:32768
    ds_read_b128 v[76:79], v11 offset:36864
    s_waitcnt vmcnt(11) lgkmcnt(6)
    v_mfma_f32_32x32x16_bf16 v[16:31], v[48:51], v[128:131], v[16:31]
    v_mfma_f32_32x32x16_bf16 v[32:47], v[52:55], v[128:131], v[32:47]
    s_add_u32 s18, s19, s20
    buffer_load_dwordx4 v[128:131], v1, s[32:35], s18 offen sc1
    s_add_u32 s20, s20, 1024
    s_cmp_eq_u32 s20, 36864
    s_cselect_b32 s20, 0, s20
    s_waitcnt vmcnt(11) lgkmcnt(4)
    v_mfma_f32_32x32x16_bf16 v[16:31], v[56:59], v[132:135], v[16:31]
    v_mfma_f32_32x32x16_bf16 v[32:47], v[60:63], v[132:135], v[32:47]
    s_add_u32 s18, s19, s20
    buffer_load_dwordx4 v[132:135], v1, s[32:35], s18 offen sc1
    s_add_u32 s20, s20, 1024
    s_cmp_eq_u32 s20, 36864
    s_cselect_b32 s20, 0, s20
    s_waitcnt vmcnt(11) lgkmcnt(2)
    v_mfma_f32_32x32x16_bf16 v[16:31], v[64:67], v[136:139], v[16:31]
    v_mfma_f32_32x32x16_bf16 v[32:47], v[68:71], v[136:139], v[32:47]
    s_add_u32 s18, s19, s20
    buffer_load_dwordx4 v[136:139], v1, s[32:35], s18 offen sc1
    s_add_u32 s20, s20, 1024
    s_cmp_eq_u32 s20, 36864
    s_cselect_b32 s20, 0, s20
    s_waitcnt vmcnt(11) lgkmcnt(0)
    v_mfma_f32_32x32x16_bf16 v[16:31], v[72:75], v[140:143], v[16:31]
    v_mfma_f32_32x32x16_bf16 v[32:47], v[76:79], v[140:143], v[32:47]
    s_add_u32 s18, s19, s20
    buffer_load_dwordx4 v[140:143], v1, s[32:35], s18 offen sc1
    s_add_u32 s20, s20, 1024
    s_cmp_eq_u32 s20, 36864
    s_cselect_b32 s20, 0, s20
    s_cmp_ge_u32 s100, 4
    s_cbranch_scc1 S_PREP
    s_cmp_eq_u32 s7, 0
    s_cbranch_scc1 S_PREP
    s_mul_i32 s25, s21, 24576
    s_sub_u32 s25, s25, 32768
    v_add_u32 v8, s25, v8
    v_add_u32 v9, s25, v9
    v_add_u32 v10, s25, v10
    v_add_u32 v11, s25, v11
    ds_read_b128 v[48:51], v8 offset:0
    ds_read_b128 v[52:55], v8 offset:4096
    ds_read_b128 v[56:59], v9 offset:0
    ds_read_b128 v[60:63], v9 offset:4096
    s_waitcnt vmcnt(11) lgkmcnt(2)
    v_mfma_f32_32x32x16_bf16 v[80:95], v[48:51], v[96:99], 0
    v_mfma_f32_32x32x16_bf16 v[64:79], v[52:55], v[96:99], 0
    ds_read_b128 v[48:51], v10 offset:0
    ds_read_b128 v[52:55], v10 offset:4096
    s_waitcnt vmcnt(10) lgkmcnt(2)
    v_mfma_f32_32x32x16_bf16 v[80:95], v[56:59], v[100:103], v[80:95]
    v_mfma_f32_32x32x16_bf16 v[64:79], v[60:63], v[100:103], v[64:79]
    ds_read_b128 v[56:59], v11 offset:0
    ds_read_b128 v[60:63], v11 offset:4096
    s_waitcnt vmcnt(9) lgkmcnt(2)
    v_mfma_f32_32x32x16_bf16 v[80:95], v[48:51], v[104:107], v[80:95]
    v_mfma_f32_32x32x16_bf16 v[64:79], v[52:55], v[104:107], v[64:79]
    ds_read_b128 v[48:51], v8 offset:8192
    ds_read_b128 v[52:55], v8 offset:12288
    s_waitcnt vmcnt(8) lgkmcnt(2)
    v_mfma_f32_32x32x16_bf16 v[80:95], v[56:59], v[108:111], v[80:95]
    v_mfma_f32_32x32x16_bf16 v[64:79], v[60:63], v[108:111], v[64:79]
    ds_read_b128 v[56:59], v9 offset:8192
    ds_read_b128 v[60:63], v9 offset:12288
    s_waitcnt vmcnt(7) lgkmcnt(2)
    v_mfma_f32_32x32x16_bf16 v[80:95], v[48:51], v[112:115], v[80:95]
    v_mfma_f32_32x32x16_bf16 v[64:79], v[52:55], v[112:115], v[64:79]
    ds_read_b128 v[48:51], v10 offset:8192
    ds_read_b128 v[52:55], v10 offset:12288
    s_waitcnt vmcnt(6) lgkmcnt(2)
    v_mfma_f32_32x32x16_bf16 v[80:95], v[56:59], v[116:119], v[80:95]
    v_mfma_f32_32x32x16_bf16 v[64:79], v[60:63], v[116:119], v[64:79]
    ds_read_b128 v[56:59], v11 offset:8192
    ds_read_b128 v[60:63], v11 offset:12288
    s_waitcnt vmcnt(5) lgkmcnt(2)
    v_mfma_f32_32x32x16_bf16 v[80:95], v[48:51], v[120:123], v[80:95]
    v_mfma_f32_32x32x16_bf16 v[64:79], v[52:55], v[120:123], v[64:79]
    ds_read_b128 v[48:51], v8 offset:16384
    ds_read_b128 v[52:55], v8 offset:20480
    s_waitcnt vmcnt(4) lgkmcnt(2)
    v_mfma_f32_32x32x16_bf16 v[80:95], v[56:59], v[124:127], v[80:95]
    v_mfma_f32_32x32x16_bf16 v[64:79], v[60:63], v[124:127], v[64:79]
    ds_read_b128 v[56:59], v9 offset:16384
    ds_read_b128 v[60:63], v9 offset:20480
    s_waitcnt vmcnt(3) lgkmcnt(2)
    v_mfma_f32_32x32x16_bf16 v[80:95], v[48:51], v[128:131], v[80:95]
    v_mfma_f32_32x32x16_bf16 v[64:79], v[52:55], v[128:131], v[64:79]
    ds_read_b128 v[48:51], v10 offset:16384
    ds_read_b128 v[52:55], v10 offset:20480
    s_waitcnt vmcnt(2) lgkmcnt(2)
    v_mfma_f32_32x32x16_bf16 v[80:95], v[56:59], v[132:135], v[80:95]
    v_mfma_f32_32x32x16_bf16 v[64:79], v[60:63], v[132:135], v[64:79]
    ds_read_b128 v[56:59], v11 offset:16384
    ds_read_b128 v[60:63], v11 offset:20480
    s_waitcnt vmcnt(1) lgkmcnt(2)
    v_mfma_f32_32x32x16_bf16 v[80:95], v[48:51], v[136:139], v[80:95]
    v_mfma_f32_32x32x16_bf16 v[64:79], v[52:55], v[136:139], v[64:79]
    s_waitcnt vmcnt(0) lgkmcnt(0)
    v_mfma_f32_32x32x16_bf16 v[80:95], v[56:59], v[140:143], v[80:95]
    v_mfma_f32_32x32x16_bf16 v[64:79], v[60:63], v[140:143], v[64:79]
    s_mov_b64 exec, 1
    ds_add_u32 v2, v3 offset:76
    s_mov_b64 exec, -1
    s_branch S_NOX
S_PREP:
    s_mov_b64 exec, 1
    ds_add_u32 v2, v3 offset:76
    s_mov_b64 exec, -1
    s_waitcnt vmcnt(0)
    s_cmp_eq_u32 s31, 0
    s_cbranch_scc1 S_PS0
    v_lshrrev_b32 v9, 5, v0
    v_lshl_add_u32 v10, v9, 9, v1
    s_cmp_eq_u32 s31, 1
    s_cbranch_scc1 S_PS1
    v_bfe_u32 v10, v0, 4, 1
    v_mul_u32_u24 v10, 36864, v10
    v_lshl_add_u32 v10, v9, 9, v10
    v_and_b32 v8, 15, v0
    v_lshl_add_u32 v10, v8, 5, v10
S_PS1:
    buffer_store_dwordx4 v[80:83], v10, s[32:35], s14 offen sc1
    buffer_store_dwordx4 v[84:87], v10, s[32:35], s12 offen sc1
    s_add_u32 s14, s14, s13
    s_add_u32 s12, s12, s13
    buffer_store_dwordx4 v[88:91], v10, s[32:35], s14 offen sc1
    buffer_store_dwordx4 v[92:95], v10, s[32:35], s12 offen sc1
S_PS0:
S_NOX:
    s_setprio 3
    s_lshr_b32 s24, s100, 2
    s_or_b32 s24, s24, s7
    s_cbranch_scc0 S_OWN
SP_72:
    ds_read_b32 v4, v2 offset:76
    s_waitcnt lgkmcnt(0)
    v_readfirstlane_b32 s24, v4
    s_cmp_ge_u32 s24, 4
    s_cbranch_scc1 SD_73
    s_sleep 1
    s_sub_u32 s72, s72, 1
    s_cbranch_scc0 SP_72
    s_mov_b32 s72, 0
SD_73:
    s_cmp_ge_u32 s100, 4
    s_cbranch_scc1 S_B2
    s_lshl_b32 s24, s21, 13
    s_add_u32 s24, s24, 77824
    s_cmp_eq_u32 s7, 3
    s_cselect_b32 s24, 136192, s24
    v_add_u32 v8, s24, v1
    ds_write_b128 v8, v[64:67] offset:0
    ds_write_b128 v8, v[68:71] offset:1024
    ds_write_b128 v8, v[72:75] offset:2048
    ds_write_b128 v8, v[76:79] offset:3072
    ds_write_b128 v8, v[80:83] offset:4096
    ds_write_b128 v8, v[84:87] offset:5120
    ds_write_b128 v8, v[88:91] offset:6144
    ds_write_b128 v8, v[92:95] offset:7168
    s_waitcnt lgkmcnt(0)
    s_mov_b64 exec, 1
    ds_add_u32 v2, v3 offset:80
    s_mov_b64 exec, -1
S_B2:
    s_cmp_lg_u32 s7, 3
    s_cbranch_scc1 S_B3
    s_sub_u32 s24, 8, s7
    s_mul_i32 s24, s24, 19456
    s_add_u32 s25, s24, 524288
    s_add_u32 m0, s24, 0
    s_add_u32 s26, s25, 0
    buffer_load_dwordx4 v1, s[32:35], s26 offen offset:0 sc1 lds
    buffer_load_dwordx4 v1, s[32:35], s26 offen offset:1024 sc1 lds
    buffer_load_dwordx4 v1, s[32:35], s26 offen offset:2048 sc1 lds
    buffer_load_dwordx4 v1, s[32:35], s26 offen offset:3072 sc1 lds
    s_add_u32 m0, s24, 4096
    s_add_u32 s26, s25, 4096
    buffer_load_dwordx4 v1, s[32:35], s26 offen offset:0 sc1 lds
    buffer_load_dwordx4 v1, s[32:35], s26 offen offset:1024 sc1 lds
    buffer_load_dwordx4 v1, s[32:35], s26 offen offset:2048 sc1 lds
    buffer_load_dwordx4 v1, s[32:35], s26 offen offset:3072 sc1 lds
    s_add_u32 m0, s24, 8192
    s_add_u32 s26, s25, 8192
    buffer_load_dwordx4 v1, s[32:35], s26 offen offset:0 sc1 lds
    buffer_load_dwordx4 v1, s[32:35], s26 offen offset:1024 sc1 lds
    buffer_load_dwordx4 v1, s[32:35], s26 offen offset:2048 sc1 lds
    buffer_load_dwordx4 v1, s[32:35], s26 offen offset:3072 sc1 lds
    s_add_u32 m0, s24, 12288
    s_add_u32 s26, s25, 12288
    buffer_load_dwordx4 v1, s[32:35], s26 offen offset:0 sc1 lds
    buffer_load_dwordx4 v1, s[32:35], s26 offen offset:1024 sc1 lds
    buffer_load_dwordx4 v1, s[32:35], s26 offen offset:2048 sc1 lds
    buffer_load_dwordx4 v1, s[32:35], s26 offen offset:3072 sc1 lds
    s_add_u32 m0, s24, 16384
    s_add_u32 s26, s25, 16384
    buffer_load_dwordx4 v1, s[32:35], s26 offen offset:0 sc1 lds
    buffer_load_dwordx4 v1, s[32:35], s26 offen offset:1024 sc1 lds
    buffer_load_dwordx4 v1, s[32:35], s26 offen offset:2048 sc1 lds
S_B3:
    v_permlane16_swap_b32 v16, v32
    v_permlane16_swap_b32 v17, v33
    v_permlane16_swap_b32 v18, v34
    v_permlane16_swap_b32 v19, v35
    v_permlane16_swap_b32 v20, v36
    v_permlane16_swap_b32 v21, v37
    v_permlane16_swap_b32 v22, v38
    v_permlane16_swap_b32 v23, v39
    v_permlane16_swap_b32 v24, v40
    v_permlane16_swap_b32 v25, v41
    v_permlane16_swap_b32 v26, v42
    v_permlane16_swap_b32 v27, v43
    v_permlane16_swap_b32 v28, v44
    v_permlane16_swap_b32 v29, v45
    v_permlane16_swap_b32 v30, v46
    v_permlane16_swap_b32 v31, v47
    s_nop 1
    v_fma_f32 v50, v144, v16, v17
    v_fma_f32 v51, v144, v32, v33
    v_fma_f32 v50, -v145, v32, v50
    v_fma_f32 v51, v145, v16, v51
    v_fma_f32 v48, v144, v50, v18
    v_fma_f32 v49, v144, v51, v34
    v_fma_f32 v48, -v145, v51, v48
    v_fma_f32 v49, v145, v50, v49
    v_fma_f32 v50, v144, v48, v19
    v_fma_f32 v51, v144, v49, v35
    v_fma_f32 v50, -v145, v49, v50
    v_fma_f32 v51, v145, v48, v51
    v_fma_f32 v48, v144, v50, v20
    v_fma_f32 v49, v144, v51, v36
    v_fma_f32 v48, -v145, v51, v48
    v_fma_f32 v49, v145, v50, v49
    v_fma_f32 v50, v144, v48, v21
    v_fma_f32 v51, v144, v49, v37
    v_fma_f32 v50, -v145, v49, v50
    v_fma_f32 v51, v145, v48, v51
    v_fma_f32 v48, v144, v50, v22
    v_fma_f32 v49, v144, v51, v38
    v_fma_f32 v48, -v145, v51, v48
    v_fma_f32 v49, v145, v50, v49
    v_fma_f32 v50, v144, v48, v23
    v_fma_f32 v51, v144, v49, v39
    v_fma_f32 v50, -v145, v49, v50
    v_fma_f32 v51, v145, v48, v51
    v_fma_f32 v48, v144, v50, v24
    v_fma_f32 v49, v144, v51, v40
    v_fma_f32 v48, -v145, v51, v48
    v_fma_f32 v49, v145, v50, v49
    v_fma_f32 v50, v144, v48, v25
    v_fma_f32 v51, v144, v49, v41
    v_fma_f32 v50, -v145, v49, v50
    v_fma_f32 v51, v145, v48, v51
    v_fma_f32 v48, v144, v50, v26
    v_fma_f32 v49, v144, v51, v42
    v_fma_f32 v48, -v145, v51, v48
    v_fma_f32 v49, v145, v50, v49
    v_fma_f32 v50, v144, v48, v27
    v_fma_f32 v51, v144, v49, v43
    v_fma_f32 v50, -v145, v49, v50
    v_fma_f32 v51, v145, v48, v51
    v_fma_f32 v48, v144, v50, v28
    v_fma_f32 v49, v144, v51, v44
    v_fma_f32 v48, -v145, v51, v48
    v_fma_f32 v49, v145, v50, v49
    v_fma_f32 v50, v144, v48, v29
    v_fma_f32 v51, v144, v49, v45
    v_fma_f32 v50, -v145, v49, v50
    v_fma_f32 v51, v145, v48, v51
    v_fma_f32 v48, v144, v50, v30
    v_fma_f32 v49, v144, v51, v46
    v_fma_f32 v48, -v145, v51, v48
    v_fma_f32 v49, v145, v50, v49
    v_fma_f32 v50, v144, v48, v31
    v_fma_f32 v51, v144, v49, v47
    v_fma_f32 v50, -v145, v49, v50
    v_fma_f32 v51, v145, v48, v51
    ds_write_b64 v5, v[50:51]
    ds_read_b64 v[134:135], v6 offset:0
    ds_read_b64 v[136:137], v6 offset:128
    ds_read_b64 v[138:139], v6 offset:256
    ds_read_b64 v[52:53], v6 offset:384
    s_lshl_b32 s25, s8, 14
    s_lshl_b32 s26, s4, 8
    s_add_u32 s25, s25, s26
    s_add_u32 s25, s25, 4071424
    v_mov_b32 v57, s73
    v_mov_b32 v59, s73
    s_waitcnt lgkmcnt(0)
    v_fma_f32 v48, v146, v134, v136
    v_fma_f32 v49, v146, v135, v137
    v_fma_f32 v48, -v147, v135, v48
    v_fma_f32 v49, v147, v134, v49
    v_fma_f32 v50, v146, v48, v138
    v_fma_f32 v51, v146, v49, v139
    v_fma_f32 v50, -v147, v49, v50
    v_fma_f32 v51, v147, v48, v51
    v_fma_f32 v56, v146, v50, v52
    v_fma_f32 v58, v146, v51, v53
    v_fma_f32 v56, -v147, v51, v56
    v_fma_f32 v58, v147, v50, v58
    s_mov_b64 exec, 0xffff
    buffer_store_dwordx4 v[56:59], v1, s[32:35], s25 offen sc1
    s_mov_b64 exec, -1
    s_waitcnt vmcnt(1)
    s_cmp_lg_u32 s7, 3
    s_cbranch_scc1 S_B4
    s_sub_u32 s24, 8, s7
    s_lshl_b32 s24, s24, 2
    v_add_u32 v11, s24, v2
    s_mov_b64 exec, 1
    v_mov_b32 v10, 0x10000
    ds_add_u32 v11, v10 offset:0
    s_mov_b64 exec, -1
S_B4:
    s_cmp_lt_u32 s75, 4
    s_cbranch_scc1 S_NOPO
    s_lshl_b32 s25, s4, 7
    s_lshl_b32 s26, s75, 2
    s_add_u32 s25, s25, s26
    s_add_u32 s25, s25, 16368
    s_mov_b64 exec, 1
    ds_add_rtn_u32 v4, v2, v3 offset:100
    s_waitcnt lgkmcnt(0)
    v_readfirstlane_b32 s24, v4
    s_mov_b64 exec, -1
    s_cmp_lg_u32 s24, 3
    s_cbranch_scc1 LF_74
    v_lshlrev_b32 v4, 13, v0
    v_mov_b32 v80, s73
    s_mov_b64 exec, 1
    buffer_store_dword v80, v4, s[32:35], s25 offen sc1
    s_mov_b64 exec, -1
LF_74:
S_NOPO:
    s_sub_u32 s24, s7, 1
    s_cmp_ge_u32 s24, 2
    s_cbranch_scc1 S_P2
    s_lshr_b32 s24, s100, 2
    s_lshr_b32 s25, s7, 1
    s_or_b32 s24, s24, s25
    s_cbranch_scc1 S_OS
SP_75:
    ds_read_b32 v4, v2 offset:80
    s_waitcnt lgkmcnt(0)
    v_readfirstlane_b32 s24, v4
    s_cmp_ge_u32 s24, 4
    s_cbranch_scc1 SD_76
    s_sleep 1
    s_sub_u32 s72, s72, 1
    s_cbranch_scc0 SP_75
    s_mov_b32 s72, 0
SD_76:
S_OS:
    s_sub_u32 s24, 8, s7
    s_mul_i32 s24, s24, 19456
    s_add_u32 s25, s24, 524288
    s_add_u32 m0, s24, 0
    s_add_u32 s26, s25, 0
    buffer_load_dwordx4 v1, s[32:35], s26 offen offset:0 sc1 lds
    buffer_load_dwordx4 v1, s[32:35], s26 offen offset:1024 sc1 lds
    buffer_load_dwordx4 v1, s[32:35], s26 offen offset:2048 sc1 lds
    buffer_load_dwordx4 v1, s[32:35], s26 offen offset:3072 sc1 lds
    s_add_u32 m0, s24, 4096
    s_add_u32 s26, s25, 4096
    buffer_load_dwordx4 v1, s[32:35], s26 offen offset:0 sc1 lds
    buffer_load_dwordx4 v1, s[32:35], s26 offen offset:1024 sc1 lds
    buffer_load_dwordx4 v1, s[32:35], s26 offen offset:2048 sc1 lds
    buffer_load_dwordx4 v1, s[32:35], s26 offen offset:3072 sc1 lds
    s_add_u32 m0, s24, 8192
    s_add_u32 s26, s25, 8192
    buffer_load_dwordx4 v1, s[32:35], s26 offen offset:0 sc1 lds
    buffer_load_dwordx4 v1, s[32:35], s26 offen offset:1024 sc1 lds
    buffer_load_dwordx4 v1, s[32:35], s26 offen offset:2048 sc1 lds
    buffer_load_dwordx4 v1, s[32:35], s26 offen offset:3072 sc1 lds
    s_add_u32 m0, s24, 12288
    s_add_u32 s26, s25, 12288
    buffer_load_dwordx4 v1, s[32:35], s26 offen offset:0 sc1 lds
    buffer_load_dwordx4 v1, s[32:35], s26 offen offset:1024 sc1 lds
    buffer_load_dwordx4 v1, s[32:35], s26 offen offset:2048 sc1 lds
    buffer_load_dwordx4 v1, s[32:35], s26 offen offset:3072 sc1 lds
    s_add_u32 m0, s24, 16384
    s_add_u32 s26, s25, 16384
    buffer_load_dwordx4 v1, s[32:35], s26 offen offset:0 sc1 lds
    buffer_load_dwordx4 v1, s[32:35], s26 offen offset:1024 sc1 lds
    buffer_load_dwordx4 v1, s[32:35], s26 offen offset:2048 sc1 lds
    s_branch S_P2
S_OWN:
    s_nop 3
    v_permlane16_swap_b32 v16, v32
    v_permlane16_swap_b32 v17, v33
    v_permlane16_swap_b32 v18, v34
    v_permlane16_swap_b32 v19, v35
    v_permlane16_swap_b32 v20, v36
    v_permlane16_swap_b32 v21, v37
    v_permlane16_swap_b32 v22, v38
    v_permlane16_swap_b32 v23, v39
    v_permlane16_swap_b32 v24, v40
    v_permlane16_swap_b32 v25, v41
    v_permlane16_swap_b32 v26, v42
    v_permlane16_swap_b32 v27, v43
    v_permlane16_swap_b32 v28, v44
    v_permlane16_swap_b32 v29, v45
    v_permlane16_swap_b32 v30, v46
    v_permlane16_swap_b32 v31, v47
    s_nop 1
    v_fma_f32 v50, v144, v16, v17
    v_fma_f32 v51, v144, v32, v33
    v_fma_f32 v50, -v145, v32, v50
    v_fma_f32 v51, v145, v16, v51
    v_fma_f32 v48, v144, v50, v18
    v_fma_f32 v49, v144, v51, v34
    v_fma_f32 v48, -v145, v51, v48
    v_fma_f32 v49, v145, v50, v49
    v_fma_f32 v50, v144, v48, v19
    v_fma_f32 v51, v144, v49, v35
    v_fma_f32 v50, -v145, v49, v50
    v_fma_f32 v51, v145, v48, v51
    v_fma_f32 v48, v144, v50, v20
    v_fma_f32 v49, v144, v51, v36
    v_fma_f32 v48, -v145, v51, v48
    v_fma_f32 v49, v145, v50, v49
    v_fma_f32 v50, v144, v48, v21
    v_fma_f32 v51, v144, v49, v37
    v_fma_f32 v50, -v145, v49, v50
    v_fma_f32 v51, v145, v48, v51
    v_fma_f32 v48, v144, v50, v22
    v_fma_f32 v49, v144, v51, v38
    v_fma_f32 v48, -v145, v51, v48
    v_fma_f32 v49, v145, v50, v49
    v_fma_f32 v50, v144, v48, v23
    v_fma_f32 v51, v144, v49, v39
    v_fma_f32 v50, -v145, v49, v50
    v_fma_f32 v51, v145, v48, v51
    v_fma_f32 v48, v144, v50, v24
    v_fma_f32 v49, v144, v51, v40
    v_fma_f32 v48, -v145, v51, v48
    v_fma_f32 v49, v145, v50, v49
    v_fma_f32 v50, v144, v48, v25
    v_fma_f32 v51, v144, v49, v41
    v_fma_f32 v50, -v145, v49, v50
    v_fma_f32 v51, v145, v48, v51
    v_fma_f32 v48, v144, v50, v26
    v_fma_f32 v49, v144, v51, v42
    v_fma_f32 v48, -v145, v51, v48
    v_fma_f32 v49, v145, v50, v49
    v_fma_f32 v50, v144, v48, v27
    v_fma_f32 v51, v144, v49, v43
    v_fma_f32 v50, -v145, v49, v50
    v_fma_f32 v51, v145, v48, v51
    v_fma_f32 v48, v144, v50, v28
    v_fma_f32 v49, v144, v51, v44
    v_fma_f32 v48, -v145, v51, v48
    v_fma_f32 v49, v145, v50, v49
    v_fma_f32 v50, v144, v48, v29
    v_fma_f32 v51, v144, v49, v45
    v_fma_f32 v50, -v145, v49, v50
    v_fma_f32 v51, v145, v48, v51
    v_fma_f32 v48, v144, v50, v30
    v_fma_f32 v49, v144, v51, v46
    v_fma_f32 v48, -v145, v51, v48
    v_fma_f32 v49, v145, v50, v49
    v_fma_f32 v50, v144, v48, v31
    v_fma_f32 v51, v144, v49, v47
    v_fma_f32 v50, -v145, v49, v50
    v_fma_f32 v51, v145, v48, v51
    ds_write_b64 v5, v[50:51]
    ds_read_b64 v[134:135], v6 offset:0
    ds_read_b64 v[136:137], v6 offset:128
    ds_read_b64 v[138:139], v6 offset:256
    ds_read_b64 v[52:53], v6 offset:384
    s_lshl_b32 s25, s8, 14
    s_lshl_b32 s26, s4, 8
    s_add_u32 s25, s25, s26
    s_add_u32 s25, s25, 4071424
    v_mov_b32 v57, s73
    v_mov_b32 v59, s73
    s_waitcnt lgkmcnt(0)
    v_fma_f32 v48, v146, v134, v136
    v_fma_f32 v49, v146, v135, v137
    v_fma_f32 v48, -v147, v135, v48
    v_fma_f32 v49, v147, v134, v49
    v_fma_f32 v50, v146, v48, v138
    v_fma_f32 v51, v146, v49, v139
    v_fma_f32 v50, -v147, v49, v50
    v_fma_f32 v51, v147, v48, v51
    v_fma_f32 v56, v146, v50, v52
    v_fma_f32 v58, v146, v51, v53
    v_fma_f32 v56, -v147, v51, v56
    v_fma_f32 v58, v147, v50, v58
    s_mov_b64 exec, 0xffff
    buffer_store_dwordx4 v[56:59], v1, s[32:35], s25 offen sc1
    s_mov_b64 exec, -1
SP_77:
    ds_read_b32 v4, v2 offset:80
    s_waitcnt lgkmcnt(0)
    v_readfirstlane_b32 s24, v4
    s_cmp_ge_u32 s24, 3
    s_cbranch_scc1 SD_78
    s_sleep 1
    s_sub_u32 s72, s72, 1
    s_cbranch_scc0 SP_77
    s_mov_b32 s72, 0
SD_78:
    v_add_u32 v8, 77824, v1
    ds_read_b128 v[64:67], v8 offset:0
    ds_read_b128 v[68:71], v8 offset:1024
    ds_read_b128 v[72:75], v8 offset:2048
    ds_read_b128 v[76:79], v8 offset:3072
    ds_read_b128 v[80:83], v8 offset:4096
    ds_read_b128 v[84:87], v8 offset:5120
    ds_read_b128 v[88:91], v8 offset:6144
    ds_read_b128 v[92:95], v8 offset:7168
    s_waitcnt lgkmcnt(4)
    ds_read_b128 v[96:99], v8 offset:8192
    ds_read_b128 v[100:103], v8 offset:9216
    ds_read_b128 v[104:107], v8 offset:10240
    ds_read_b128 v[108:111], v8 offset:11264
    ds_read_b128 v[112:115], v8 offset:12288
    ds_read_b128 v[116:119], v8 offset:13312
    ds_read_b128 v[120:123], v8 offset:14336
    ds_read_b128 v[124:127], v8 offset:15360
    s_waitcnt lgkmcnt(0)
    v_add_f32 v64, v64, v96
    v_add_f32 v65, v65, v97
    v_add_f32 v66, v66, v98
    v_add_f32 v67, v67, v99
    v_add_f32 v68, v68, v100
    v_add_f32 v69, v69, v101
    v_add_f32 v70, v70, v102
    v_add_f32 v71, v71, v103
    v_add_f32 v72, v72, v104
    v_add_f32 v73, v73, v105
    v_add_f32 v74, v74, v106
    v_add_f32 v75, v75, v107
    v_add_f32 v76, v76, v108
    v_add_f32 v77, v77, v109
    v_add_f32 v78, v78, v110
    v_add_f32 v79, v79, v111
    v_add_f32 v80, v80, v112
    v_add_f32 v81, v81, v113
    v_add_f32 v82, v82, v114
    v_add_f32 v83, v83, v115
    v_add_f32 v84, v84, v116
    v_add_f32 v85, v85, v117
    v_add_f32 v86, v86, v118
    v_add_f32 v87, v87, v119
    v_add_f32 v88, v88, v120
    v_add_f32 v89, v89, v121
    v_add_f32 v90, v90, v122
    v_add_f32 v91, v91, v123
    v_add_f32 v92, v92, v124
    v_add_f32 v93, v93, v125
    v_add_f32 v94, v94, v126
    v_add_f32 v95, v95, v127
    v_add_u32 v8, 136192, v1
    ds_read_b128 v[96:99], v8 offset:0
    ds_read_b128 v[100:103], v8 offset:1024
    ds_read_b128 v[104:107], v8 offset:2048
    ds_read_b128 v[108:111], v8 offset:3072
    ds_read_b128 v[112:115], v8 offset:4096
    ds_read_b128 v[116:119], v8 offset:5120
    ds_read_b128 v[120:123], v8 offset:6144
    ds_read_b128 v[124:127], v8 offset:7168
    s_waitcnt lgkmcnt(0)
    s_mov_b64 exec, 1
    ds_add_u32 v2, v3 offset:80
    s_mov_b64 exec, -1
    v_add_f32 v64, v64, v96
    v_add_f32 v65, v65, v97
    v_add_f32 v66, v66, v98
    v_add_f32 v67, v67, v99
    v_add_f32 v68, v68, v100
    v_add_f32 v69, v69, v101
    v_add_f32 v70, v70, v102
    v_add_f32 v71, v71, v103
    v_add_f32 v72, v72, v104
    v_add_f32 v73, v73, v105
    v_add_f32 v74, v74, v106
    v_add_f32 v75, v75, v107
    v_add_f32 v76, v76, v108
    v_add_f32 v77, v77, v109
    v_add_f32 v78, v78, v110
    v_add_f32 v79, v79, v111
    v_add_f32 v80, v80, v112
    v_add_f32 v81, v81, v113
    v_add_f32 v82, v82, v114
    v_add_f32 v83, v83, v115
    v_add_f32 v84, v84, v116
    v_add_f32 v85, v85, v117
    v_add_f32 v86, v86, v118
    v_add_f32 v87, v87, v119
    v_add_f32 v88, v88, v120
    v_add_f32 v89, v89, v121
    v_add_f32 v90, v90, v122
    v_add_f32 v91, v91, v123
    v_add_f32 v92, v92, v124
    v_add_f32 v93, v93, v125
    v_add_f32 v94, v94, v126
    v_add_f32 v95, v95, v127
    s_nop 1
    v_permlane16_swap_b32 v80, v64
    v_permlane16_swap_b32 v81, v65
    v_permlane16_swap_b32 v82, v66
    v_permlane16_swap_b32 v83, v67
    v_permlane16_swap_b32 v84, v68
    v_permlane16_swap_b32 v85, v69
    v_permlane16_swap_b32 v86, v70
    v_permlane16_swap_b32 v87, v71
    v_permlane16_swap_b32 v88, v72
    v_permlane16_swap_b32 v89, v73
    v_permlane16_swap_b32 v90, v74
    v_permlane16_swap_b32 v91, v75
    v_permlane16_swap_b32 v92, v76
    v_permlane16_swap_b32 v93, v77
    v_permlane16_swap_b32 v94, v78
    v_permlane16_swap_b32 v95, v79
    s_nop 1
    v_fma_f32 v50, v152, v80, v81
    v_fma_f32 v51, v152, v64, v65
    v_fma_f32 v50, -v153, v64, v50
    v_fma_f32 v51, v153, v80, v51
    v_fma_f32 v48, v152, v50, v82
    v_fma_f32 v49, v152, v51, v66
    v_fma_f32 v48, -v153, v51, v48
    v_fma_f32 v49, v153, v50, v49
    v_fma_f32 v50, v152, v48, v83
    v_fma_f32 v51, v152, v49, v67
    v_fma_f32 v50, -v153, v49, v50
    v_fma_f32 v51, v153, v48, v51
    v_fma_f32 v48, v152, v50, v84
    v_fma_f32 v49, v152, v51, v68
    v_fma_f32 v48, -v153, v51, v48
    v_fma_f32 v49, v153, v50, v49
    v_fma_f32 v50, v152, v48, v85
    v_fma_f32 v51, v152, v49, v69
    v_fma_f32 v50, -v153, v49, v50
    v_fma_f32 v51, v153, v48, v51
    v_fma_f32 v48, v152, v50, v86
    v_fma_f32 v49, v152, v51, v70
    v_fma_f32 v48, -v153, v51, v48
    v_fma_f32 v49, v153, v50, v49
    v_fma_f32 v50, v152, v48, v87
    v_fma_f32 v51, v152, v49, v71
    v_fma_f32 v50, -v153, v49, v50
    v_fma_f32 v51, v153, v48, v51
    v_fma_f32 v48, v152, v50, v88
    v_fma_f32 v49, v152, v51, v72
    v_fma_f32 v48, -v153, v51, v48
    v_fma_f32 v49, v153, v50, v49
    v_fma_f32 v50, v152, v48, v89
    v_fma_f32 v51, v152, v49, v73
    v_fma_f32 v50, -v153, v49, v50
    v_fma_f32 v51, v153, v48, v51
    v_fma_f32 v48, v152, v50, v90
    v_fma_f32 v49, v152, v51, v74
    v_fma_f32 v48, -v153, v51, v48
    v_fma_f32 v49, v153, v50, v49
    v_fma_f32 v50, v152, v48, v91
    v_fma_f32 v51, v152, v49, v75
    v_fma_f32 v50, -v153, v49, v50
    v_fma_f32 v51, v153, v48, v51
    v_fma_f32 v48, v152, v50, v92
    v_fma_f32 v49, v152, v51, v76
    v_fma_f32 v48, -v153, v51, v48
    v_fma_f32 v49, v153, v50, v49
    v_fma_f32 v50, v152, v48, v93
    v_fma_f32 v51, v152, v49, v77
    v_fma_f32 v50, -v153, v49, v50
    v_fma_f32 v51, v153, v48, v51
    v_fma_f32 v48, v152, v50, v94
    v_fma_f32 v49, v152, v51, v78
    v_fma_f32 v48, -v153, v51, v48
    v_fma_f32 v49, v153, v50, v49
    v_fma_f32 v50, v152, v48, v95
    v_fma_f32 v51, v152, v49, v79
    v_fma_f32 v50, -v153, v49, v50
    v_fma_f32 v51, v153, v48, v51
    ds_write_b64 v5, v[50:51]
    ds_read_b64 v[128:129], v6 offset:0
    ds_read_b64 v[130:131], v6 offset:128
    ds_read_b64 v[132:133], v6 offset:256
    ds_read_b64 v[52:53], v6 offset:384
    s_lshl_b32 s25, s11, 14
    s_lshl_b32 s26, s4, 8
    s_add_u32 s25, s25, s26
    s_add_u32 s25, s25, 4071424
    v_mov_b32 v57, s73
    v_mov_b32 v59, s73
    s_waitcnt lgkmcnt(0)
    v_fma_f32 v48, v154, v128, v130
    v_fma_f32 v49, v154, v129, v131
    v_fma_f32 v48, -v155, v129, v48
    v_fma_f32 v49, v155, v128, v49
    v_fma_f32 v50, v154, v48, v132
    v_fma_f32 v51, v154, v49, v133
    v_fma_f32 v50, -v155, v49, v50
    v_fma_f32 v51, v155, v48, v51
    v_fma_f32 v56, v154, v50, v52
    v_fma_f32 v58, v154, v51, v53
    v_fma_f32 v56, -v155, v51, v56
    v_fma_f32 v58, v155, v50, v58
    s_mov_b64 exec, 0xffff
    buffer_store_dwordx4 v[56:59], v1, s[32:35], s25 offen sc1
    s_mov_b64 exec, -1
S_P2:
    s_lshl_b32 s25, s8, 14
    s_lshl_b32 s26, s4, 8
    s_add_u32 s25, s25, s26
    s_add_u32 s25, s25, 4063232
PL_79:
    buffer_load_dwordx4 v[96:99], v7, s[32:35], s25 offen offset:0 sc1
    buffer_load_dwordx4 v[100:103], v7, s[32:35], s25 offen offset:256 sc1
    buffer_load_dwordx4 v[104:107], v7, s[32:35], s25 offen offset:512 sc1
    buffer_load_dwordx4 v[108:111], v7, s[32:35], s25 offen offset:768 sc1
    buffer_load_dwordx4 v[112:115], v7, s[32:35], s25 offen offset:1024 sc1
    buffer_load_dwordx4 v[116:119], v7, s[32:35], s25 offen offset:1280 sc1
    buffer_load_dwordx4 v[120:123], v7, s[32:35], s25 offen offset:1536 sc1
    buffer_load_dwordx4 v[124:127], v7, s[32:35], s25 offen offset:1792 sc1
    s_waitcnt vmcnt(0)
    v_xor_b32 v4, s73, v97
    v_bitop3_b32 v4, v4, v99, s73 bitop3:0xf6
    v_bitop3_b32 v4, v4, v101, s73 bitop3:0xf6
    v_bitop3_b32 v4, v4, v103, s73 bitop3:0xf6
    v_bitop3_b32 v4, v4, v105, s73 bitop3:0xf6
    v_bitop3_b32 v4, v4, v107, s73 bitop3:0xf6
    v_bitop3_b32 v4, v4, v109, s73 bitop3:0xf6
    v_bitop3_b32 v4, v4, v111, s73 bitop3:0xf6
    v_bitop3_b32 v4, v4, v113, s73 bitop3:0xf6
    v_bitop3_b32 v4, v4, v115, s73 bitop3:0xf6
    v_bitop3_b32 v4, v4, v117, s73 bitop3:0xf6
    v_bitop3_b32 v4, v4, v119, s73 bitop3:0xf6
    v_bitop3_b32 v4, v4, v121, s73 bitop3:0xf6
    v_bitop3_b32 v4, v4, v123, s73 bitop3:0xf6
    v_bitop3_b32 v4, v4, v125, s73 bitop3:0xf6
    v_bitop3_b32 v4, v4, v127, s73 bitop3:0xf6
    v_cmp_ne_u32 vcc, 0, v4
    s_cbranch_vccz PD_80
    s_mov_b64 exec, vcc
    s_sleep 3
    s_sub_u32 s72, s72, 1
    s_cbranch_scc0 PL_79
    s_mov_b32 s72, 0
PD_80:
    s_mov_b64 exec, -1
    s_sub_u32 s24, s7, 1
    s_cmp_ge_u32 s24, 2
    s_cbranch_scc1 S_LATE1
    s_sub_u32 s24, 8, s7
    s_lshl_b32 s24, s24, 2
    v_add_u32 v11, s24, v2
    s_mov_b64 exec, 1
    v_mov_b32 v10, 0x10000
    ds_add_u32 v11, v10 offset:0
    s_mov_b64 exec, -1
S_LATE1:
    v_fma_f32 v50, v148, v96, v100
    v_fma_f32 v51, v148, v98, v102
    v_fma_f32 v50, -v149, v98, v50
    v_fma_f32 v51, v149, v96, v51
    v_fma_f32 v48, v148, v50, v104
    v_fma_f32 v49, v148, v51, v106
    v_fma_f32 v48, -v149, v51, v48
    v_fma_f32 v49, v149, v50, v49
    v_fma_f32 v50, v148, v48, v108
    v_fma_f32 v51, v148, v49, v110
    v_fma_f32 v50, -v149, v49, v50
    v_fma_f32 v51, v149, v48, v51
    v_fma_f32 v48, v148, v50, v112
    v_fma_f32 v49, v148, v51, v114
    v_fma_f32 v48, -v149, v51, v48
    v_fma_f32 v49, v149, v50, v49
    v_fma_f32 v50, v148, v48, v116
    v_fma_f32 v51, v148, v49, v118
    v_fma_f32 v50, -v149, v49, v50
    v_fma_f32 v51, v149, v48, v51
    v_fma_f32 v48, v148, v50, v120
    v_fma_f32 v49, v148, v51, v122
    v_fma_f32 v48, -v149, v51, v48
    v_fma_f32 v49, v149, v50, v49
    v_fma_f32 v50, v148, v48, v124
    v_fma_f32 v51, v148, v49, v126
    v_fma_f32 v50, -v149, v49, v50
    v_fma_f32 v51, v149, v48, v51
    s_lshr_b32 s24, s100, 2
    s_or_b32 s24, s24, s7
    s_cbranch_scc1 S_E2
    s_lshl_b32 s25, s11, 14
    s_lshl_b32 s26, s4, 8
    s_add_u32 s25, s25, s26
    s_add_u32 s25, s25, 4063232
    buffer_load_dwordx4 v[96:99], v7, s[32:35], s25 offen offset:0 sc1
    buffer_load_dwordx4 v[100:103], v7, s[32:35], s25 offen offset:256 sc1
    buffer_load_dwordx4 v[104:107], v7, s[32:35], s25 offen offset:512 sc1
    buffer_load_dwordx4 v[108:111], v7, s[32:35], s25 offen offset:768 sc1
    buffer_load_dwordx4 v[112:115], v7, s[32:35], s25 offen offset:1024 sc1
    buffer_load_dwordx4 v[116:119], v7, s[32:35], s25 offen offset:1280 sc1
    buffer_load_dwordx4 v[120:123], v7, s[32:35], s25 offen offset:1536 sc1
    buffer_load_dwordx4 v[124:127], v7, s[32:35], s25 offen offset:1792 sc1
S_E2:
    ds_write_b64 v12, v[50:51]
    ds_read_b64 v[52:53], v6 offset:0
    ds_read_b64 v[54:55], v6 offset:128
    ds_read_b64 v[56:57], v6 offset:256
    ds_read_b64 v[58:59], v6 offset:384
    v_sub_f32 v60, 0, v145
    s_waitcnt lgkmcnt(0)
    v_fma_f32 v48, v150, v58, v56
    v_fma_f32 v49, v150, v59, v57
    v_fma_f32 v48, -v151, v59, v48
    v_fma_f32 v49, v151, v58, v49
    v_fma_f32 v50, v150, v48, v54
    v_fma_f32 v51, v150, v49, v55
    v_fma_f32 v50, -v151, v49, v50
    v_fma_f32 v51, v151, v48, v51
    v_fma_f32 v48, v150, v50, v52
    v_fma_f32 v49, v150, v51, v53
    v_fma_f32 v48, -v151, v51, v48
    v_fma_f32 v49, v151, v50, v49
    s_mov_b32 exec_lo, 0xffff0000
    s_mov_b32 exec_hi, 0xffffffff
    v_fma_f32 v50, v146, v48, v134
    v_fma_f32 v51, v147, v48, v135
    v_fma_f32 v48, -v147, v49, v50
    v_fma_f32 v49, v146, v49, v51
    s_mov_b32 exec_lo, 0xffff0000
    s_mov_b32 exec_hi, 0xffff0000
    v_fma_f32 v50, v146, v48, v136
    v_fma_f32 v51, v147, v48, v137
    v_fma_f32 v48, -v147, v49, v50
    v_fma_f32 v49, v146, v49, v51
    s_mov_b32 exec_lo, 0x0
    s_mov_b32 exec_hi, 0xffff0000
    v_fma_f32 v50, v146, v48, v138
    v_fma_f32 v51, v147, v48, v139
    v_fma_f32 v48, -v147, v49, v50
    v_fma_f32 v49, v146, v49, v51
    s_mov_b64 exec, -1
    s_mul_i32 s25, s4, 144
    s_lshl_b32 s26, s8, 1
    s_add_u32 s25, s25, s26
    s_lshl_b32 s25, s25, 10
    s_add_u32 s25, s25, 4718592
    v_fmac_f32 v16, v144, v48
    v_fmac_f32 v32, v144, v49
    v_fmac_f32 v16, v60, v49
    v_fmac_f32 v32, v145, v48
    v_cvt_pk_bf16_f32 v52, v16, v32
    ds_write_b32 v13, v52 offset:0
    v_fmac_f32 v17, v144, v16
    v_fmac_f32 v33, v144, v32
    v_fmac_f32 v17, v60, v32
    v_fmac_f32 v33, v145, v16
    v_cvt_pk_bf16_f32 v53, v17, v33
    ds_write_b32 v13, v53 offset:16
    v_fmac_f32 v18, v144, v17
    v_fmac_f32 v34, v144, v33
    v_fmac_f32 v18, v60, v33
    v_fmac_f32 v34, v145, v17
    v_cvt_pk_bf16_f32 v54, v18, v34
    ds_write_b32 v13, v54 offset:32
    v_fmac_f32 v19, v144, v18
    v_fmac_f32 v35, v144, v34
    v_fmac_f32 v19, v60, v34
    v_fmac_f32 v35, v145, v18
    v_cvt_pk_bf16_f32 v55, v19, v35
    ds_write_b32 v13, v55 offset:48
    ds_read_b128 v[8:11], v14
    v_fmac_f32 v20, v144, v19
    v_fmac_f32 v36, v144, v35
    v_fmac_f32 v20, v60, v35
    v_fmac_f32 v36, v145, v19
    s_waitcnt lgkmcnt(0)
    buffer_store_dwordx4 v[8:11], v15, s[32:35], s25 offen offset:0 sc1
    v_cvt_pk_bf16_f32 v52, v20, v36
    ds_write_b32 v13, v52 offset:0
    v_fmac_f32 v21, v144, v20
    v_fmac_f32 v37, v144, v36
    v_fmac_f32 v21, v60, v36
    v_fmac_f32 v37, v145, v20
    v_cvt_pk_bf16_f32 v53, v21, v37
    ds_write_b32 v13, v53 offset:16
    v_fmac_f32 v22, v144, v21
    v_fmac_f32 v38, v144, v37
    v_fmac_f32 v22, v60, v37
    v_fmac_f32 v38, v145, v21
    v_cvt_pk_bf16_f32 v54, v22, v38
    ds_write_b32 v13, v54 offset:32
    v_fmac_f32 v23, v144, v22
    v_fmac_f32 v39, v144, v38
    v_fmac_f32 v23, v60, v38
    v_fmac_f32 v39, v145, v22
    v_cvt_pk_bf16_f32 v55, v23, v39
    ds_write_b32 v13, v55 offset:48
    ds_read_b128 v[140:143], v14
    v_fmac_f32 v24, v144, v23
    v_fmac_f32 v40, v144, v39
    v_fmac_f32 v24, v60, v39
    v_fmac_f32 v40, v145, v23
    s_waitcnt lgkmcnt(0)
    buffer_store_dwordx4 v[140:143], v15, s[32:35], s25 offen offset:128 sc1
    v_cvt_pk_bf16_f32 v52, v24, v40
    ds_write_b32 v13, v52 offset:0
    v_fmac_f32 v25, v144, v24
    v_fmac_f32 v41, v144, v40
    v_fmac_f32 v25, v60, v40
    v_fmac_f32 v41, v145, v24
    v_cvt_pk_bf16_f32 v53, v25, v41
    ds_write_b32 v13, v53 offset:16
    v_fmac_f32 v26, v144, v25
    v_fmac_f32 v42, v144, v41
    v_fmac_f32 v26, v60, v41
    v_fmac_f32 v42, v145, v25
    v_cvt_pk_bf16_f32 v54, v26, v42
    ds_write_b32 v13, v54 offset:32
    v_fmac_f32 v27, v144, v26
    v_fmac_f32 v43, v144, v42
    v_fmac_f32 v27, v60, v42
    v_fmac_f32 v43, v145, v26
    v_cvt_pk_bf16_f32 v55, v27, v43
    ds_write_b32 v13, v55 offset:48
    ds_read_b128 v[8:11], v14
    v_fmac_f32 v28, v144, v27
    v_fmac_f32 v44, v144, v43
    v_fmac_f32 v28, v60, v43
    v_fmac_f32 v44, v145, v27
    s_waitcnt lgkmcnt(0)
    buffer_store_dwordx4 v[8:11], v15, s[32:35], s25 offen offset:256 sc1
    v_cvt_pk_bf16_f32 v52, v28, v44
    ds_write_b32 v13, v52 offset:0
    v_fmac_f32 v29, v144, v28
    v_fmac_f32 v45, v144, v44
    v_fmac_f32 v29, v60, v44
    v_fmac_f32 v45, v145, v28
    v_cvt_pk_bf16_f32 v53, v29, v45
    ds_write_b32 v13, v53 offset:16
    v_fmac_f32 v30, v144, v29
    v_fmac_f32 v46, v144, v45
    v_fmac_f32 v30, v60, v45
    v_fmac_f32 v46, v145, v29
    v_cvt_pk_bf16_f32 v54, v30, v46
    ds_write_b32 v13, v54 offset:32
    v_fmac_f32 v31, v144, v30
    v_fmac_f32 v47, v144, v46
    v_fmac_f32 v31, v60, v46
    v_fmac_f32 v47, v145, v30
    v_cvt_pk_bf16_f32 v55, v31, v47
    ds_write_b32 v13, v55 offset:48
    ds_read_b128 v[140:143], v14
    s_waitcnt lgkmcnt(0)
    buffer_store_dwordx4 v[140:143], v15, s[32:35], s25 offen offset:384 sc1
    s_cmp_ge_u32 s100, 4
    s_cbranch_scc1 S_HF
    s_cmp_lg_u32 s7, 0
    s_cbranch_scc1 S_HF
    s_nop 1
    s_lshl_b32 s25, s11, 14
    s_lshl_b32 s26, s4, 8
    s_add_u32 s25, s25, s26
    s_add_u32 s25, s25, 4063232
    s_waitcnt vmcnt(4)
    s_branch PL_81_c
PL_81:
    buffer_load_dwordx4 v[96:99], v7, s[32:35], s25 offen offset:0 sc1
    buffer_load_dwordx4 v[100:103], v7, s[32:35], s25 offen offset:256 sc1
    buffer_load_dwordx4 v[104:107], v7, s[32:35], s25 offen offset:512 sc1
    buffer_load_dwordx4 v[108:111], v7, s[32:35], s25 offen offset:768 sc1
    buffer_load_dwordx4 v[112:115], v7, s[32:35], s25 offen offset:1024 sc1
    buffer_load_dwordx4 v[116:119], v7, s[32:35], s25 offen offset:1280 sc1
    buffer_load_dwordx4 v[120:123], v7, s[32:35], s25 offen offset:1536 sc1
    buffer_load_dwordx4 v[124:127], v7, s[32:35], s25 offen offset:1792 sc1
    s_waitcnt vmcnt(0)
PL_81_c:
    v_xor_b32 v4, s73, v97
    v_bitop3_b32 v4, v4, v99, s73 bitop3:0xf6
    v_bitop3_b32 v4, v4, v101, s73 bitop3:0xf6
    v_bitop3_b32 v4, v4, v103, s73 bitop3:0xf6
    v_bitop3_b32 v4, v4, v105, s73 bitop3:0xf6
    v_bitop3_b32 v4, v4, v107, s73 bitop3:0xf6
    v_bitop3_b32 v4, v4, v109, s73 bitop3:0xf6
    v_bitop3_b32 v4, v4, v111, s73 bitop3:0xf6
    v_bitop3_b32 v4, v4, v113, s73 bitop3:0xf6
    v_bitop3_b32 v4, v4, v115, s73 bitop3:0xf6
    v_bitop3_b32 v4, v4, v117, s73 bitop3:0xf6
    v_bitop3_b32 v4, v4, v119, s73 bitop3:0xf6
    v_bitop3_b32 v4, v4, v121, s73 bitop3:0xf6
    v_bitop3_b32 v4, v4, v123, s73 bitop3:0xf6
    v_bitop3_b32 v4, v4, v125, s73 bitop3:0xf6
    v_bitop3_b32 v4, v4, v127, s73 bitop3:0xf6
    v_cmp_ne_u32 vcc, 0, v4
    s_cbranch_vccz PD_82
    s_mov_b64 exec, vcc
    s_sleep 3
    s_sub_u32 s72, s72, 1
    s_cbranch_scc0 PL_81
    s_mov_b32 s72, 0
PD_82:
    s_mov_b64 exec, -1
    v_fma_f32 v50, v156, v96, v100
    v_fma_f32 v51, v156, v98, v102
    v_fma_f32 v50, -v157, v98, v50
    v_fma_f32 v51, v157, v96, v51
    v_fma_f32 v48, v156, v50, v104
    v_fma_f32 v49, v156, v51, v106
    v_fma_f32 v48, -v157, v51, v48
    v_fma_f32 v49, v157, v50, v49
    v_fma_f32 v50, v156, v48, v108
    v_fma_f32 v51, v156, v49, v110
    v_fma_f32 v50, -v157, v49, v50
    v_fma_f32 v51, v157, v48, v51
    v_fma_f32 v48, v156, v50, v112
    v_fma_f32 v49, v156, v51, v114
    v_fma_f32 v48, -v157, v51, v48
    v_fma_f32 v49, v157, v50, v49
    v_fma_f32 v50, v156, v48, v116
    v_fma_f32 v51, v156, v49, v118
    v_fma_f32 v50, -v157, v49, v50
    v_fma_f32 v51, v157, v48, v51
    v_fma_f32 v48, v156, v50, v120
    v_fma_f32 v49, v156, v51, v122
    v_fma_f32 v48, -v157, v51, v48
    v_fma_f32 v49, v157, v50, v49
    v_fma_f32 v50, v156, v48, v124
    v_fma_f32 v51, v156, v49, v126
    v_fma_f32 v50, -v157, v49, v50
    v_fma_f32 v51, v157, v48, v51
    ds_write_b64 v12, v[50:51]
    ds_read_b64 v[52:53], v6 offset:0
    ds_read_b64 v[54:55], v6 offset:128
    ds_read_b64 v[56:57], v6 offset:256
    ds_read_b64 v[58:59], v6 offset:384
    v_sub_f32 v60, 0, v153
    s_waitcnt lgkmcnt(0)
    v_fma_f32 v48, v158, v58, v56
    v_fma_f32 v49, v158, v59, v57
    v_fma_f32 v48, -v159, v59, v48
    v_fma_f32 v49, v159, v58, v49
    v_fma_f32 v50, v158, v48, v54
    v_fma_f32 v51, v158, v49, v55
    v_fma_f32 v50, -v159, v49, v50
    v_fma_f32 v51, v159, v48, v51
    v_fma_f32 v48, v158, v50, v52
    v_fma_f32 v49, v158, v51, v53
    v_fma_f32 v48, -v159, v51, v48
    v_fma_f32 v49, v159, v50, v49
    s_mov_b32 exec_lo, 0xffff0000
    s_mov_b32 exec_hi, 0xffffffff
    v_fma_f32 v50, v154, v48, v128
    v_fma_f32 v51, v155, v48, v129
    v_fma_f32 v48, -v155, v49, v50
    v_fma_f32 v49, v154, v49, v51
    s_mov_b32 exec_lo, 0xffff0000
    s_mov_b32 exec_hi, 0xffff0000
    v_fma_f32 v50, v154, v48, v130
    v_fma_f32 v51, v155, v48, v131
    v_fma_f32 v48, -v155, v49, v50
    v_fma_f32 v49, v154, v49, v51
    s_mov_b32 exec_lo, 0x0
    s_mov_b32 exec_hi, 0xffff0000
    v_fma_f32 v50, v154, v48, v132
    v_fma_f32 v51, v155, v48, v133
    v_fma_f32 v48, -v155, v49, v50
    v_fma_f32 v49, v154, v49, v51
    s_mov_b64 exec, -1
    s_waitcnt vmcnt(0)
    s_mul_i32 s25, s4, 36
    s_add_u32 s25, s25, s8
    s_lshl_b32 s25, s25, 7
    s_add_u32 s25, s25, 360448
    v_lshlrev_b32 v4, 13, v0
    v_mov_b32 v61, s73
    s_mov_b64 exec, 1
    buffer_store_dword v61, v4, s[32:35], s25 offen sc1
    s_mov_b64 exec, -1
    s_mul_i32 s25, s4, 144
    s_lshl_b32 s26, s11, 1
    s_add_u32 s25, s25, s26
    s_lshl_b32 s25, s25, 10
    s_add_u32 s25, s25, 4718592
    v_fmac_f32 v80, v152, v48
    v_fmac_f32 v64, v152, v49
    v_fmac_f32 v80, v60, v49
    v_fmac_f32 v64, v153, v48
    v_cvt_pk_bf16_f32 v52, v80, v64
    ds_write_b32 v13, v52 offset:0
    v_fmac_f32 v81, v152, v80
    v_fmac_f32 v65, v152, v64
    v_fmac_f32 v81, v60, v64
    v_fmac_f32 v65, v153, v80
    v_cvt_pk_bf16_f32 v53, v81, v65
    ds_write_b32 v13, v53 offset:16
    v_fmac_f32 v82, v152, v81
    v_fmac_f32 v66, v152, v65
    v_fmac_f32 v82, v60, v65
    v_fmac_f32 v66, v153, v81
    v_cvt_pk_bf16_f32 v54, v82, v66
    ds_write_b32 v13, v54 offset:32
    v_fmac_f32 v83, v152, v82
    v_fmac_f32 v67, v152, v66
    v_fmac_f32 v83, v60, v66
    v_fmac_f32 v67, v153, v82
    v_cvt_pk_bf16_f32 v55, v83, v67
    ds_write_b32 v13, v55 offset:48
    ds_read_b128 v[8:11], v14
    v_fmac_f32 v84, v152, v83
    v_fmac_f32 v68, v152, v67
    v_fmac_f32 v84, v60, v67
    v_fmac_f32 v68, v153, v83
    s_waitcnt lgkmcnt(0)
    buffer_store_dwordx4 v[8:11], v15, s[32:35], s25 offen offset:0 sc1
    v_cvt_pk_bf16_f32 v52, v84, v68
    ds_write_b32 v13, v52 offset:0
    v_fmac_f32 v85, v152, v84
    v_fmac_f32 v69, v152, v68
    v_fmac_f32 v85, v60, v68
    v_fmac_f32 v69, v153, v84
    v_cvt_pk_bf16_f32 v53, v85, v69
    ds_write_b32 v13, v53 offset:16
    v_fmac_f32 v86, v152, v85
    v_fmac_f32 v70, v152, v69
    v_fmac_f32 v86, v60, v69
    v_fmac_f32 v70, v153, v85
    v_cvt_pk_bf16_f32 v54, v86, v70
    ds_write_b32 v13, v54 offset:32
    v_fmac_f32 v87, v152, v86
    v_fmac_f32 v71, v152, v70
    v_fmac_f32 v87, v60, v70
    v_fmac_f32 v71, v153, v86
    v_cvt_pk_bf16_f32 v55, v87, v71
    ds_write_b32 v13, v55 offset:48
    ds_read_b128 v[140:143], v14
    v_fmac_f32 v88, v152, v87
    v_fmac_f32 v72, v152, v71
    v_fmac_f32 v88, v60, v71
    v_fmac_f32 v72, v153, v87
    s_waitcnt lgkmcnt(0)
    buffer_store_dwordx4 v[140:143], v15, s[32:35], s25 offen offset:128 sc1
    v_cvt_pk_bf16_f32 v52, v88, v72
    ds_write_b32 v13, v52 offset:0
    v_fmac_f32 v89, v152, v88
    v_fmac_f32 v73, v152, v72
    v_fmac_f32 v89, v60, v72
    v_fmac_f32 v73, v153, v88
    v_cvt_pk_bf16_f32 v53, v89, v73
    ds_write_b32 v13, v53 offset:16
    v_fmac_f32 v90, v152, v89
    v_fmac_f32 v74, v152, v73
    v_fmac_f32 v90, v60, v73
    v_fmac_f32 v74, v153, v89
    v_cvt_pk_bf16_f32 v54, v90, v74
    ds_write_b32 v13, v54 offset:32
    v_fmac_f32 v91, v152, v90
    v_fmac_f32 v75, v152, v74
    v_fmac_f32 v91, v60, v74
    v_fmac_f32 v75, v153, v90
    v_cvt_pk_bf16_f32 v55, v91, v75
    ds_write_b32 v13, v55 offset:48
    ds_read_b128 v[8:11], v14
    v_fmac_f32 v92, v152, v91
    v_fmac_f32 v76, v152, v75
    v_fmac_f32 v92, v60, v75
    v_fmac_f32 v76, v153, v91
    s_waitcnt lgkmcnt(0)
    buffer_store_dwordx4 v[8:11], v15, s[32:35], s25 offen offset:256 sc1
    v_cvt_pk_bf16_f32 v52, v92, v76
    ds_write_b32 v13, v52 offset:0
    v_fmac_f32 v93, v152, v92
    v_fmac_f32 v77, v152, v76
    v_fmac_f32 v93, v60, v76
    v_fmac_f32 v77, v153, v92
    v_cvt_pk_bf16_f32 v53, v93, v77
    ds_write_b32 v13, v53 offset:16
    v_fmac_f32 v94, v152, v93
    v_fmac_f32 v78, v152, v77
    v_fmac_f32 v94, v60, v77
    v_fmac_f32 v78, v153, v93
    v_cvt_pk_bf16_f32 v54, v94, v78
    ds_write_b32 v13, v54 offset:32
    v_fmac_f32 v95, v152, v94
    v_fmac_f32 v79, v152, v78
    v_fmac_f32 v95, v60, v78
    v_fmac_f32 v79, v153, v94
    v_cvt_pk_bf16_f32 v55, v95, v79
    ds_write_b32 v13, v55 offset:48
    ds_read_b128 v[140:143], v14
    s_waitcnt lgkmcnt(0)
    buffer_store_dwordx4 v[140:143], v15, s[32:35], s25 offen offset:384 sc1
    s_mov_b32 s8, s11
S_HF:
    v_lshlrev_b32 v62, 7, v0
    s_mov_b32 s18, 16384
    s_cmp_eq_u32 s7, 1
    s_cselect_b32 exec_lo, -1, 1
    s_mov_b32 exec_hi, 0
    buffer_load_dwordx4 v[64:67], v62, s[32:35], s18 offen sc1
    s_mov_b64 exec, -1
    s_waitcnt vmcnt(1)
    s_mul_i32 s25, s4, 36
    s_add_u32 s25, s25, s8
    s_lshl_b32 s25, s25, 7
    s_add_u32 s25, s25, 360448
    v_lshlrev_b32 v4, 13, v0
    v_mov_b32 v61, s73
    s_mov_b64 exec, 1
    buffer_store_dword v61, v4, s[32:35], s25 offen sc1
    s_mov_b64 exec, -1
    s_cmp_lg_u32 s7, 1
    s_cbranch_scc1 S_NOPR
    s_mov_b32 exec_hi, 0
    s_waitcnt vmcnt(1)
    s_branch PL_83_c
PL_83:
    buffer_load_dwordx4 v[64:67], v62, s[32:35], s18 offen sc1
    s_waitcnt vmcnt(0)
PL_83_c:
    v_xor_b32 v4, s73, v64
    v_bitop3_b32 v4, v4, v65, s73 bitop3:0xf6
    v_bitop3_b32 v4, v4, v66, s73 bitop3:0xf6
    v_bitop3_b32 v4, v4, v67, s73 bitop3:0xf6
    v_cmp_ne_u32 vcc, 0, v4
    s_cbranch_vccz PD_84
    s_mov_b64 exec, vcc
    s_sleep 8
    s_sub_u32 s72, s72, 1
    s_cbranch_scc0 PL_83
    s_mov_b32 s72, 0
PD_84:
    s_mov_b64 exec, 1
    ds_add_u32 v2, v3 offset:104
    s_mov_b64 exec, -1
S_NOPR:
    s_mul_i32 s24, s7, 18
    s_lshr_b32 s25, s7, 1
    s_lshl_b32 s22, s4, 1
    s_and_b32 s31, s101, 1
    s_add_u32 s23, s22, s31
    s_xor_b32 s27, s23, s25
    s_xor_b32 s28, s23, 1
    s_mul_i32 s12, s23, 72
    s_add_u32 s12, s12, s24
    s_lshl_b32 s12, s12, 10
    s_add_u32 s12, s12, 4718592
    s_mul_i32 s13, s28, 72
    s_add_u32 s13, s13, s24
    s_lshl_b32 s13, s13, 10
    s_add_u32 s13, s13, 4718592
    s_and_b32 s28, s7, 1
    s_lshl_b32 s29, s5, 1
    s_add_u32 s29, s29, s28
    s_xor_b32 s28, s29, 1
    s_mul_i32 s14, s29, 72
    s_add_u32 s14, s14, s24
    s_lshl_b32 s14, s14, 10
    s_add_u32 s14, s14, 2015232
    s_mul_i32 s15, s28, 72
    s_add_u32 s15, s15, s24
    s_lshl_b32 s15, s15, 10
    s_add_u32 s15, s15, 2015232
    s_lshr_b32 s30, s101, 1
    s_add_u32 s30, s30, 14
    s_mul_i32 s16, s30, 72
    s_add_u32 s16, s16, s24
    s_lshl_b32 s16, s16, 10
    s_add_u32 s16, s16, 2015232
    s_cmp_lt_u32 s101, 4
    s_cselect_b32 s16, 12582912, s16
    s_lshr_b32 s31, s101, 2
    v_lshlrev_b32 v5, 7, v0
    s_cmp_ge_u32 s7, 2
    s_cbranch_scc1 S_U2
    v_lshlrev_b32 v16, 16, v160
    v_and_b32 v17, 0xffff0000, v160
    v_lshlrev_b32 v18, 16, v161
    v_and_b32 v19, 0xffff0000, v161
    v_lshlrev_b32 v20, 16, v162
    v_and_b32 v21, 0xffff0000, v162
    v_lshlrev_b32 v22, 16, v163
    v_and_b32 v23, 0xffff0000, v163
    v_lshlrev_b32 v24, 16, v164
    v_and_b32 v25, 0xffff0000, v164
    v_lshlrev_b32 v26, 16, v165
    v_and_b32 v27, 0xffff0000, v165
    v_lshlrev_b32 v28, 16, v166
    v_and_b32 v29, 0xffff0000, v166
    v_lshlrev_b32 v30, 16, v167
    v_and_b32 v31, 0xffff0000, v167
    s_branch S_U3
S_U2:
    v_lshlrev_b32 v48, 16, v160
    v_and_b32 v49, 0xffff0000, v160
    v_lshlrev_b32 v50, 16, v161
    v_and_b32 v51, 0xffff0000, v161
    v_lshlrev_b32 v52, 16, v162
    v_and_b32 v53, 0xffff0000, v162
    v_lshlrev_b32 v54, 16, v163
    v_and_b32 v55, 0xffff0000, v163
    v_lshlrev_b32 v56, 16, v164
    v_and_b32 v57, 0xffff0000, v164
    v_lshlrev_b32 v58, 16, v165
    v_and_b32 v59, 0xffff0000, v165
    v_lshlrev_b32 v60, 16, v166
    v_and_b32 v61, 0xffff0000, v166
    v_lshlrev_b32 v62, 16, v167
    v_and_b32 v63, 0xffff0000, v167
S_U3:
    s_cmp_eq_u32 s31, 0
    s_cbranch_scc1 S_U4
    s_cmp_eq_u32 s7, 1
    s_cbranch_scc1 S_U5
    v_mov_b32 v80, 0
    v_mov_b32 v81, 0
    v_mov_b32 v82, 0
    v_mov_b32 v83, 0
    v_mov_b32 v84, 0
    v_mov_b32 v85, 0
    v_mov_b32 v86, 0
    v_mov_b32 v87, 0
    v_mov_b32 v88, 0
    v_mov_b32 v89, 0
    v_mov_b32 v90, 0
    v_mov_b32 v91, 0
    v_mov_b32 v92, 0
    v_mov_b32 v93, 0
    v_mov_b32 v94, 0
    v_mov_b32 v95, 0
    s_branch S_U4
S_U5:
    v_lshlrev_b32 v80, 16, v152
    v_and_b32 v81, 0xffff0000, v152
    v_lshlrev_b32 v82, 16, v153
    v_and_b32 v83, 0xffff0000, v153
    v_lshlrev_b32 v84, 16, v154
    v_and_b32 v85, 0xffff0000, v154
    v_lshlrev_b32 v86, 16, v155
    v_and_b32 v87, 0xffff0000, v155
    v_lshlrev_b32 v88, 16, v156
    v_and_b32 v89, 0xffff0000, v156
    v_lshlrev_b32 v90, 16, v157
    v_and_b32 v91, 0xffff0000, v157
    v_lshlrev_b32 v92, 16, v158
    v_and_b32 v93, 0xffff0000, v158
    v_lshlrev_b32 v94, 16, v159
    v_and_b32 v95, 0xffff0000, v159
S_U4:
    s_sub_u32 s9, 3, s7
    s_mul_i32 s9, s9, 18432
    s_add_u32 s9, s9, 19456
    s_mul_i32 s10, s29, 36864
    s_mul_i32 s11, s28, 36864
    s_lshl_b32 s17, s7, 13
    s_add_u32 s17, s17, 3342336
    s_add_u32 s10, s10, s17
    s_add_u32 s11, s11, s17
    s_mul_i32 s17, s7, 7168
    s_sub_u32 s17, 32768, s17
SP_85:
    ds_read_b32 v4, v2 offset:104
    s_waitcnt lgkmcnt(0)
    v_readfirstlane_b32 s24, v4
    s_cmp_ge_u32 s24, 1
    s_cbranch_scc1 SD_86
    s_sleep 4
    s_sub_u32 s72, s72, 1
    s_cbranch_scc0 SP_85
    s_mov_b32 s72, 0
SD_86:
    buffer_load_dwordx4 v[104:107], v1, s[32:35], s14 offen offset:0 sc1
    buffer_load_dwordx4 v[108:111], v1, s[32:35], s15 offen offset:0 sc1
    buffer_load_dwordx4 v[112:115], v1, s[32:35], s16 offen offset:0 sc1
    buffer_load_dwordx4 v[124:127], v1, s[32:35], s14 offen offset:1024 sc1
    buffer_load_dwordx4 v[128:131], v1, s[32:35], s15 offen offset:1024 sc1
    buffer_load_dwordx4 v[132:135], v1, s[32:35], s16 offen offset:1024 sc1
    buffer_load_dwordx4 v[144:147], v1, s[32:35], s14 offen offset:2048 sc1
    buffer_load_dwordx4 v[148:151], v1, s[32:35], s15 offen offset:2048 sc1
    buffer_load_dwordx4 v[152:155], v1, s[32:35], s16 offen offset:2048 sc1
    s_mul_i32 s18, s4, 36
    s_mul_i32 s19, s7, 9
    s_add_u32 s18, s18, s19
    s_lshl_b32 s18, s18, 7
    s_add_u32 s18, s18, 360448
    s_mov_b64 exec, 0x1ff
    s_cmp_eq_u32 s7, 3
    s_cselect_b32 exec_lo, 31, exec_lo
PL_87:
    buffer_load_dword v6, v5, s[32:35], s18 offen sc1
    s_waitcnt vmcnt(0)
    v_xor_b32 v4, s73, v6
    v_cmp_ne_u32 vcc, 0, v4
    s_cbranch_vccz PD_88
    s_mov_b64 exec, vcc
    s_sleep 3
    s_sub_u32 s72, s72, 1
    s_cbranch_scc0 PL_87
    s_mov_b32 s72, 0
PD_88:
    s_mov_b64 exec, -1
    buffer_load_dwordx4 v[96:99], v1, s[32:35], s12 offen offset:0 sc1
    buffer_load_dwordx4 v[100:103], v1, s[32:35], s13 offen offset:0 sc1
    buffer_load_dwordx4 v[116:119], v1, s[32:35], s12 offen offset:1024 sc1
    buffer_load_dwordx4 v[120:123], v1, s[32:35], s13 offen offset:1024 sc1
    buffer_load_dwordx4 v[136:139], v1, s[32:35], s12 offen offset:2048 sc1
    buffer_load_dwordx4 v[140:143], v1, s[32:35], s13 offen offset:2048 sc1
    s_mov_b64 exec, 1
    ds_add_rtn_u32 v4, v2, v3 offset:84
    s_waitcnt lgkmcnt(0)
    v_readfirstlane_b32 s24, v4
    s_mov_b64 exec, -1
    s_cmp_lg_u32 s24, 3
    s_cbranch_scc1 S_NG
    s_lshl_b32 s21, s4, 8
    s_add_u32 s21, s21, 40960
    v_lshlrev_b32 v12, 2, v0
    s_mov_b32 m0, 161536
    s_nop 0
    buffer_load_dword v12, s[32:35], s21 offen sc1 lds
    s_mov_b32 m0, 161792
    s_sub_u32 s21, s21, 8192
    buffer_load_dword v12, s[32:35], s21 offen sc1 lds
    s_waitcnt vmcnt(0)
    s_mov_b64 exec, 1
    ds_add_u32 v2, v3 offset:88
    s_mov_b64 exec, -1
    s_mov_b64 exec, 1
    v_mov_b32 v12, 0x10000
    ds_add_u32 v2, v12 offset:32
    s_mov_b64 exec, -1
S_NG:
SP_89:
    ds_read_b32 v4, v2 offset:20
    s_waitcnt lgkmcnt(0)
    v_readfirstlane_b32 s24, v4
    s_and_b32 s24, s24, 0xff
    s_cmp_ge_u32 s24, 8
    s_cbranch_scc1 SD_90
    s_sleep 4
    s_sub_u32 s72, s72, 1
    s_cbranch_scc0 SP_89
    s_mov_b32 s72, 0
SD_90:
    s_setprio 3
    s_waitcnt vmcnt(4)
    s_cmp_ge_u32 s7, 2
    s_cbranch_scc1 S_F2
    v_mfma_f32_32x32x16_bf16 v[16:31], v[96:99], v[104:107], v[16:31]
    v_mfma_f32_32x32x16_bf16 v[48:63], v[100:103], v[104:107], 0
    s_branch S_F3
S_F2:
    v_mfma_f32_32x32x16_bf16 v[16:31], v[96:99], v[104:107], 0
    v_mfma_f32_32x32x16_bf16 v[48:63], v[100:103], v[104:107], v[48:63]
S_F3:
    v_mfma_f32_32x32x16_bf16 v[32:47], v[96:99], v[108:111], 0
    v_mfma_f32_32x32x16_bf16 v[64:79], v[100:103], v[108:111], 0
    s_cmp_eq_u32 s31, 0
    s_cbranch_scc1 S_E_91
    v_mfma_f32_32x32x16_bf16 v[80:95], v[96:99], v[112:115], v[80:95]
S_E_91:
    buffer_load_dwordx4 v[96:99], v1, s[32:35], s12 offen offset:3072 sc1
    buffer_load_dwordx4 v[100:103], v1, s[32:35], s13 offen offset:3072 sc1
    buffer_load_dwordx4 v[104:107], v1, s[32:35], s14 offen offset:3072 sc1
    buffer_load_dwordx4 v[108:111], v1, s[32:35], s15 offen offset:3072 sc1
    buffer_load_dwordx4 v[112:115], v1, s[32:35], s16 offen offset:3072 sc1
    s_add_u32 s12, s12, 4096
    s_add_u32 s13, s13, 4096
    s_add_u32 s14, s14, 4096
    s_add_u32 s15, s15, 4096
    s_add_u32 s16, s16, 4096
    s_add_u32 m0, s9, 0
    s_mov_b32 s21, 0
    s_and_b32 s21, s21, 7
    s_lshl_b32 s21, s21, 10
    s_add_u32 s21, s21, s10
    buffer_load_dwordx4 v1, s[32:35], s21 offen sc1 lds
    s_waitcnt vmcnt(8)
    v_mfma_f32_32x32x16_bf16 v[16:31], v[116:119], v[124:127], v[16:31]
    v_mfma_f32_32x32x16_bf16 v[48:63], v[120:123], v[124:127], v[48:63]
    v_mfma_f32_32x32x16_bf16 v[32:47], v[116:119], v[128:131], v[32:47]
    v_mfma_f32_32x32x16_bf16 v[64:79], v[120:123], v[128:131], v[64:79]
    s_cmp_eq_u32 s31, 0
    s_cbranch_scc1 S_E_92
    v_mfma_f32_32x32x16_bf16 v[80:95], v[116:119], v[132:135], v[80:95]
S_E_92:
    buffer_load_dwordx4 v[116:119], v1, s[32:35], s12 offen offset:0 sc1
    buffer_load_dwordx4 v[120:123], v1, s[32:35], s13 offen offset:0 sc1
    buffer_load_dwordx4 v[124:127], v1, s[32:35], s14 offen offset:0 sc1
    buffer_load_dwordx4 v[128:131], v1, s[32:35], s15 offen offset:0 sc1
    buffer_load_dwordx4 v[132:135], v1, s[32:35], s16 offen offset:0 sc1
    s_add_u32 m0, s9, 1024
    s_mov_b32 s21, 1
    s_and_b32 s21, s21, 7
    s_lshl_b32 s21, s21, 10
    s_add_u32 s21, s21, s10
    buffer_load_dwordx4 v1, s[32:35], s21 offen sc1 lds
    s_waitcnt vmcnt(12)
    v_mfma_f32_32x32x16_bf16 v[16:31], v[136:139], v[144:147], v[16:31]
    v_mfma_f32_32x32x16_bf16 v[48:63], v[140:143], v[144:147], v[48:63]
    v_mfma_f32_32x32x16_bf16 v[32:47], v[136:139], v[148:151], v[32:47]
    v_mfma_f32_32x32x16_bf16 v[64:79], v[140:143], v[148:151], v[64:79]
    s_cmp_eq_u32 s31, 0
    s_cbranch_scc1 S_E_93
    v_mfma_f32_32x32x16_bf16 v[80:95], v[136:139], v[152:155], v[80:95]
S_E_93:
    buffer_load_dwordx4 v[136:139], v1, s[32:35], s12 offen offset:1024 sc1
    buffer_load_dwordx4 v[140:143], v1, s[32:35], s13 offen offset:1024 sc1
    buffer_load_dwordx4 v[144:147], v1, s[32:35], s14 offen offset:1024 sc1
    buffer_load_dwordx4 v[148:151], v1, s[32:35], s15 offen offset:1024 sc1
    buffer_load_dwordx4 v[152:155], v1, s[32:35], s16 offen offset:1024 sc1
    s_add_u32 m0, s9, 2048
    s_mov_b32 s21, 2
    s_and_b32 s21, s21, 7
    s_lshl_b32 s21, s21, 10
    s_add_u32 s21, s21, s10
    buffer_load_dwordx4 v1, s[32:35], s21 offen sc1 lds
    s_cmp_lg_u32 s31, 0
    s_cbranch_scc1 S_PCN
    s_setprio 0
S_PCN:
    s_waitcnt vmcnt(13)
    v_mfma_f32_32x32x16_bf16 v[16:31], v[96:99], v[104:107], v[16:31]
    v_mfma_f32_32x32x16_bf16 v[48:63], v[100:103], v[104:107], v[48:63]
    v_mfma_f32_32x32x16_bf16 v[32:47], v[96:99], v[108:111], v[32:47]
    v_mfma_f32_32x32x16_bf16 v[64:79], v[100:103], v[108:111], v[64:79]
    s_cmp_eq_u32 s31, 0
    s_cbranch_scc1 S_E_94
    v_mfma_f32_32x32x16_bf16 v[80:95], v[96:99], v[112:115], v[80:95]
S_E_94:
    buffer_load_dwordx4 v[96:99], v1, s[32:35], s12 offen offset:2048 sc1
    buffer_load_dwordx4 v[100:103], v1, s[32:35], s13 offen offset:2048 sc1
    buffer_load_dwordx4 v[104:107], v1, s[32:35], s14 offen offset:2048 sc1
    buffer_load_dwordx4 v[108:111], v1, s[32:35], s15 offen offset:2048 sc1
    buffer_load_dwordx4 v[112:115], v1, s[32:35], s16 offen offset:2048 sc1
    s_add_u32 m0, s9, 3072
    s_mov_b32 s21, 3
    s_and_b32 s21, s21, 7
    s_lshl_b32 s21, s21, 10
    s_add_u32 s21, s21, s10
    buffer_load_dwordx4 v1, s[32:35], s21 offen sc1 lds
    s_waitcnt vmcnt(13)
    v_mfma_f32_32x32x16_bf16 v[16:31], v[116:119], v[124:127], v[16:31]
    v_mfma_f32_32x32x16_bf16 v[48:63], v[120:123], v[124:127], v[48:63]
    v_mfma_f32_32x32x16_bf16 v[32:47], v[116:119], v[128:131], v[32:47]
    v_mfma_f32_32x32x16_bf16 v[64:79], v[120:123], v[128:131], v[64:79]
    s_cmp_eq_u32 s31, 0
    s_cbranch_scc1 S_E_95
    v_mfma_f32_32x32x16_bf16 v[80:95], v[116:119], v[132:135], v[80:95]
S_E_95:
    buffer_load_dwordx4 v[116:119], v1, s[32:35], s12 offen offset:3072 sc1
    buffer_load_dwordx4 v[120:123], v1, s[32:35], s13 offen offset:3072 sc1
    buffer_load_dwordx4 v[124:127], v1, s[32:35], s14 offen offset:3072 sc1
    buffer_load_dwordx4 v[128:131], v1, s[32:35], s15 offen offset:3072 sc1
    buffer_load_dwordx4 v[132:135], v1, s[32:35], s16 offen offset:3072 sc1
    s_add_u32 s12, s12, 4096
    s_add_u32 s13, s13, 4096
    s_add_u32 s14, s14, 4096
    s_add_u32 s15, s15, 4096
    s_add_u32 s16, s16, 4096
    s_add_u32 m0, s9, 4096
    s_mov_b32 s21, 4
    s_and_b32 s21, s21, 7
    s_lshl_b32 s21, s21, 10
    s_add_u32 s21, s21, s10
    buffer_load_dwordx4 v1, s[32:35], s21 offen sc1 lds
    s_waitcnt vmcnt(13)
    v_mfma_f32_32x32x16_bf16 v[16:31], v[136:139], v[144:147], v[16:31]
    v_mfma_f32_32x32x16_bf16 v[48:63], v[140:143], v[144:147], v[48:63]
    v_mfma_f32_32x32x16_bf16 v[32:47], v[136:139], v[148:151], v[32:47]
    v_mfma_f32_32x32x16_bf16 v[64:79], v[140:143], v[148:151], v[64:79]
    s_cmp_eq_u32 s31, 0
    s_cbranch_scc1 S_E_96
    v_mfma_f32_32x32x16_bf16 v[80:95], v[136:139], v[152:155], v[80:95]
S_E_96:
    buffer_load_dwordx4 v[136:139], v1, s[32:35], s12 offen offset:0 sc1
    buffer_load_dwordx4 v[140:143], v1, s[32:35], s13 offen offset:0 sc1
    buffer_load_dwordx4 v[144:147], v1, s[32:35], s14 offen offset:0 sc1
    buffer_load_dwordx4 v[148:151], v1, s[32:35], s15 offen offset:0 sc1
    buffer_load_dwordx4 v[152:155], v1, s[32:35], s16 offen offset:0 sc1
    s_add_u32 m0, s9, 5120
    s_mov_b32 s21, 5
    s_and_b32 s21, s21, 7
    s_lshl_b32 s21, s21, 10
    s_add_u32 s21, s21, s10
    buffer_load_dwordx4 v1, s[32:35], s21 offen sc1 lds
    s_waitcnt vmcnt(13)
    v_mfma_f32_32x32x16_bf16 v[16:31], v[96:99], v[104:107], v[16:31]
    v_mfma_f32_32x32x16_bf16 v[48:63], v[100:103], v[104:107], v[48:63]
    v_mfma_f32_32x32x16_bf16 v[32:47], v[96:99], v[108:111], v[32:47]
    v_mfma_f32_32x32x16_bf16 v[64:79], v[100:103], v[108:111], v[64:79]
    s_cmp_eq_u32 s31, 0
    s_cbranch_scc1 S_E_97
    v_mfma_f32_32x32x16_bf16 v[80:95], v[96:99], v[112:115], v[80:95]
S_E_97:
    buffer_load_dwordx4 v[96:99], v1, s[32:35], s12 offen offset:1024 sc1
    buffer_load_dwordx4 v[100:103], v1, s[32:35], s13 offen offset:1024 sc1
    buffer_load_dwordx4 v[104:107], v1, s[32:35], s14 offen offset:1024 sc1
    buffer_load_dwordx4 v[108:111], v1, s[32:35], s15 offen offset:1024 sc1
    buffer_load_dwordx4 v[112:115], v1, s[32:35], s16 offen offset:1024 sc1
    s_add_u32 m0, s9, 6144
    s_mov_b32 s21, 6
    s_and_b32 s21, s21, 7
    s_lshl_b32 s21, s21, 10
    s_add_u32 s21, s21, s10
    buffer_load_dwordx4 v1, s[32:35], s21 offen sc1 lds
    s_waitcnt vmcnt(13)
    v_mfma_f32_32x32x16_bf16 v[16:31], v[116:119], v[124:127], v[16:31]
    v_mfma_f32_32x32x16_bf16 v[48:63], v[120:123], v[124:127], v[48:63]
    v_mfma_f32_32x32x16_bf16 v[32:47], v[116:119], v[128:131], v[32:47]
    v_mfma_f32_32x32x16_bf16 v[64:79], v[120:123], v[128:131], v[64:79]
    s_cmp_eq_u32 s31, 0
    s_cbranch_scc1 S_E_98
    v_mfma_f32_32x32x16_bf16 v[80:95], v[116:119], v[132:135], v[80:95]
S_E_98:
    s_cmp_lg_u32 s7, 3
    s_cbranch_scc1 S_CL1
    s_mov_b64 exec, 0x1e0
PL_99:
    buffer_load_dword v6, v5, s[32:35], s18 offen sc1
    s_waitcnt vmcnt(0)
    v_xor_b32 v4, s73, v6
    v_cmp_ne_u32 vcc, 0, v4
    s_cbranch_vccz PD_100
    s_mov_b64 exec, vcc
    s_sleep 3
    s_sub_u32 s72, s72, 1
    s_cbranch_scc0 PL_99
    s_mov_b32 s72, 0
PD_100:
    s_mov_b64 exec, -1
S_CL1:
    buffer_load_dwordx4 v[116:119], v1, s[32:35], s12 offen offset:2048 sc1
    buffer_load_dwordx4 v[120:123], v1, s[32:35], s13 offen offset:2048 sc1
    buffer_load_dwordx4 v[124:127], v1, s[32:35], s14 offen offset:2048 sc1
    buffer_load_dwordx4 v[128:131], v1, s[32:35], s15 offen offset:2048 sc1
    buffer_load_dwordx4 v[132:135], v1, s[32:35], s16 offen offset:2048 sc1
    s_add_u32 m0, s9, 7168
    s_mov_b32 s21, 7
    s_and_b32 s21, s21, 7
    s_lshl_b32 s21, s21, 10
    s_add_u32 s21, s21, s10
    buffer_load_dwordx4 v1, s[32:35], s21 offen sc1 lds
    s_waitcnt vmcnt(13)
    v_mfma_f32_32x32x16_bf16 v[16:31], v[136:139], v[144:147], v[16:31]
    v_mfma_f32_32x32x16_bf16 v[48:63], v[140:143], v[144:147], v[48:63]
    v_mfma_f32_32x32x16_bf16 v[32:47], v[136:139], v[148:151], v[32:47]
    v_mfma_f32_32x32x16_bf16 v[64:79], v[140:143], v[148:151], v[64:79]
    s_cmp_eq_u32 s31, 0
    s_cbranch_scc1 S_E_101
    v_mfma_f32_32x32x16_bf16 v[80:95], v[136:139], v[152:155], v[80:95]
S_E_101:
    buffer_load_dwordx4 v[136:139], v1, s[32:35], s12 offen offset:3072 sc1
    buffer_load_dwordx4 v[140:143], v1, s[32:35], s13 offen offset:3072 sc1
    buffer_load_dwordx4 v[144:147], v1, s[32:35], s14 offen offset:3072 sc1
    buffer_load_dwordx4 v[148:151], v1, s[32:35], s15 offen offset:3072 sc1
    buffer_load_dwordx4 v[152:155], v1, s[32:35], s16 offen offset:3072 sc1
    s_add_u32 s12, s12, 4096
    s_add_u32 s13, s13, 4096
    s_add_u32 s14, s14, 4096
    s_add_u32 s15, s15, 4096
    s_add_u32 s16, s16, 4096
    s_add_u32 m0, s9, 8192
    s_add_u32 s21, s10, s17
    buffer_load_dwordx4 v1, s[32:35], s21 offen sc1 lds
    s_waitcnt vmcnt(13)
    v_mfma_f32_32x32x16_bf16 v[16:31], v[96:99], v[104:107], v[16:31]
    v_mfma_f32_32x32x16_bf16 v[48:63], v[100:103], v[104:107], v[48:63]
    v_mfma_f32_32x32x16_bf16 v[32:47], v[96:99], v[108:111], v[32:47]
    v_mfma_f32_32x32x16_bf16 v[64:79], v[100:103], v[108:111], v[64:79]
    s_cmp_eq_u32 s31, 0
    s_cbranch_scc1 S_E_102
    v_mfma_f32_32x32x16_bf16 v[80:95], v[96:99], v[112:115], v[80:95]
S_E_102:
    buffer_load_dwordx4 v[96:99], v1, s[32:35], s12 offen offset:0 sc1
    buffer_load_dwordx4 v[100:103], v1, s[32:35], s13 offen offset:0 sc1
    buffer_load_dwordx4 v[104:107], v1, s[32:35], s14 offen offset:0 sc1
    buffer_load_dwordx4 v[108:111], v1, s[32:35], s15 offen offset:0 sc1
    buffer_load_dwordx4 v[112:115], v1, s[32:35], s16 offen offset:0 sc1
    s_add_u32 m0, s9, 9216
    s_mov_b32 s21, 0
    s_and_b32 s21, s21, 7
    s_lshl_b32 s21, s21, 10
    s_add_u32 s21, s21, s11
    buffer_load_dwordx4 v1, s[32:35], s21 offen sc1 lds
    s_setprio 0
S_PCN2:
    s_waitcnt vmcnt(13)
    v_mfma_f32_32x32x16_bf16 v[16:31], v[116:119], v[124:127], v[16:31]
    v_mfma_f32_32x32x16_bf16 v[48:63], v[120:123], v[124:127], v[48:63]
    v_mfma_f32_32x32x16_bf16 v[32:47], v[116:119], v[128:131], v[32:47]
    v_mfma_f32_32x32x16_bf16 v[64:79], v[120:123], v[128:131], v[64:79]
    s_cmp_eq_u32 s31, 0
    s_cbranch_scc1 S_E_103
    v_mfma_f32_32x32x16_bf16 v[80:95], v[116:119], v[132:135], v[80:95]
S_E_103:
    buffer_load_dwordx4 v[116:119], v1, s[32:35], s12 offen offset:1024 sc1
    buffer_load_dwordx4 v[120:123], v1, s[32:35], s13 offen offset:1024 sc1
    buffer_load_dwordx4 v[124:127], v1, s[32:35], s14 offen offset:1024 sc1
    buffer_load_dwordx4 v[128:131], v1, s[32:35], s15 offen offset:1024 sc1
    buffer_load_dwordx4 v[132:135], v1, s[32:35], s16 offen offset:1024 sc1
    s_add_u32 m0, s9, 10240
    s_mov_b32 s21, 1
    s_and_b32 s21, s21, 7
    s_lshl_b32 s21, s21, 10
    s_add_u32 s21, s21, s11
    buffer_load_dwordx4 v1, s[32:35], s21 offen sc1 lds
    s_waitcnt vmcnt(13)
    v_mfma_f32_32x32x16_bf16 v[16:31], v[136:139], v[144:147], v[16:31]
    v_mfma_f32_32x32x16_bf16 v[48:63], v[140:143], v[144:147], v[48:63]
    v_mfma_f32_32x32x16_bf16 v[32:47], v[136:139], v[148:151], v[32:47]
    v_mfma_f32_32x32x16_bf16 v[64:79], v[140:143], v[148:151], v[64:79]
    s_cmp_eq_u32 s31, 0
    s_cbranch_scc1 S_E_104
    v_mfma_f32_32x32x16_bf16 v[80:95], v[136:139], v[152:155], v[80:95]
S_E_104:
    buffer_load_dwordx4 v[136:139], v1, s[32:35], s12 offen offset:2048 sc1
    buffer_load_dwordx4 v[140:143], v1, s[32:35], s13 offen offset:2048 sc1
    buffer_load_dwordx4 v[144:147], v1, s[32:35], s14 offen offset:2048 sc1
    buffer_load_dwordx4 v[148:151], v1, s[32:35], s15 offen offset:2048 sc1
    buffer_load_dwordx4 v[152:155], v1, s[32:35], s16 offen offset:2048 sc1
    s_add_u32 m0, s9, 11264
    s_mov_b32 s21, 2
    s_and_b32 s21, s21, 7
    s_lshl_b32 s21, s21, 10
    s_add_u32 s21, s21, s11
    buffer_load_dwordx4 v1, s[32:35], s21 offen sc1 lds
    s_waitcnt vmcnt(13)
    v_mfma_f32_32x32x16_bf16 v[16:31], v[96:99], v[104:107], v[16:31]
    v_mfma_f32_32x32x16_bf16 v[48:63], v[100:103], v[104:107], v[48:63]
    v_mfma_f32_32x32x16_bf16 v[32:47], v[96:99], v[108:111], v[32:47]
    v_mfma_f32_32x32x16_bf16 v[64:79], v[100:103], v[108:111], v[64:79]
    s_cmp_eq_u32 s31, 0
    s_cbranch_scc1 S_E_105
    v_mfma_f32_32x32x16_bf16 v[80:95], v[96:99], v[112:115], v[80:95]
S_E_105:
    buffer_load_dwordx4 v[96:99], v1, s[32:35], s12 offen offset:3072 sc1
    buffer_load_dwordx4 v[100:103], v1, s[32:35], s13 offen offset:3072 sc1
    buffer_load_dwordx4 v[104:107], v1, s[32:35], s14 offen offset:3072 sc1
    buffer_load_dwordx4 v[108:111], v1, s[32:35], s15 offen offset:3072 sc1
    buffer_load_dwordx4 v[112:115], v1, s[32:35], s16 offen offset:3072 sc1
    s_add_u32 s12, s12, 4096
    s_add_u32 s13, s13, 4096
    s_add_u32 s14, s14, 4096
    s_add_u32 s15, s15, 4096
    s_add_u32 s16, s16, 4096
    s_add_u32 m0, s9, 12288
    s_mov_b32 s21, 3
    s_and_b32 s21, s21, 7
    s_lshl_b32 s21, s21, 10
    s_add_u32 s21, s21, s11
    buffer_load_dwordx4 v1, s[32:35], s21 offen sc1 lds
    s_waitcnt vmcnt(13)
    v_mfma_f32_32x32x16_bf16 v[16:31], v[116:119], v[124:127], v[16:31]
    v_mfma_f32_32x32x16_bf16 v[48:63], v[120:123], v[124:127], v[48:63]
    v_mfma_f32_32x32x16_bf16 v[32:47], v[116:119], v[128:131], v[32:47]
    v_mfma_f32_32x32x16_bf16 v[64:79], v[120:123], v[128:131], v[64:79]
    s_cmp_eq_u32 s31, 0
    s_cbranch_scc1 S_E_106
    v_mfma_f32_32x32x16_bf16 v[80:95], v[116:119], v[132:135], v[80:95]
S_E_106:
    buffer_load_dwordx4 v[116:119], v1, s[32:35], s12 offen offset:0 sc1
    buffer_load_dwordx4 v[120:123], v1, s[32:35], s13 offen offset:0 sc1
    buffer_load_dwordx4 v[124:127], v1, s[32:35], s14 offen offset:0 sc1
    buffer_load_dwordx4 v[128:131], v1, s[32:35], s15 offen offset:0 sc1
    buffer_load_dwordx4 v[132:135], v1, s[32:35], s16 offen offset:0 sc1
    s_add_u32 m0, s9, 13312
    s_mov_b32 s21, 4
    s_and_b32 s21, s21, 7
    s_lshl_b32 s21, s21, 10
    s_add_u32 s21, s21, s11
    buffer_load_dwordx4 v1, s[32:35], s21 offen sc1 lds
    s_waitcnt vmcnt(13)
    v_mfma_f32_32x32x16_bf16 v[16:31], v[136:139], v[144:147], v[16:31]
    v_mfma_f32_32x32x16_bf16 v[48:63], v[140:143], v[144:147], v[48:63]
    v_mfma_f32_32x32x16_bf16 v[32:47], v[136:139], v[148:151], v[32:47]
    v_mfma_f32_32x32x16_bf16 v[64:79], v[140:143], v[148:151], v[64:79]
    s_cmp_eq_u32 s31, 0
    s_cbranch_scc1 S_E_107
    v_mfma_f32_32x32x16_bf16 v[80:95], v[136:139], v[152:155], v[80:95]
S_E_107:
    buffer_load_dwordx4 v[136:139], v1, s[32:35], s12 offen offset:1024 sc1
    buffer_load_dwordx4 v[140:143], v1, s[32:35], s13 offen offset:1024 sc1
    buffer_load_dwordx4 v[144:147], v1, s[32:35], s14 offen offset:1024 sc1
    buffer_load_dwordx4 v[148:151], v1, s[32:35], s15 offen offset:1024 sc1
    buffer_load_dwordx4 v[152:155], v1, s[32:35], s16 offen offset:1024 sc1
    s_add_u32 m0, s9, 14336
    s_mov_b32 s21, 5
    s_and_b32 s21, s21, 7
    s_lshl_b32 s21, s21, 10
    s_add_u32 s21, s21, s11
    buffer_load_dwordx4 v1, s[32:35], s21 offen sc1 lds
    s_and_b32 s22, s7, 1
    s_mul_i32 s22, s22, 9216
    s_lshr_b32 s24, s7, 1
    s_mul_i32 s24, s24, 97280
    s_add_u32 s22, s22, s24
    v_add_u32 v9, s22, v1
    v_add_u32 v8, s9, v1
    s_cmp_eq_u32 s31, 0
    s_cbranch_scc1 S_W2
SP_108:
    ds_read_b32 v4, v2 offset:28
    s_waitcnt lgkmcnt(0)
    v_readfirstlane_b32 s24, v4
    s_and_b32 s24, s24, 0xff
    s_cmp_ge_u32 s24, 8
    s_cbranch_scc1 SD_109
    s_sleep 8
    s_sub_u32 s72, s72, 1
    s_cbranch_scc0 SP_108
    s_mov_b32 s72, 0
SD_109:
    s_mul_i32 s24, s30, 36864
    s_add_u32 s24, s24, 3342336
    s_lshl_b32 s25, s7, 13
    s_add_u32 s25, s25, s24
    s_add_u32 m0, s22, 0
    s_mov_b32 s21, 0
    s_and_b32 s21, s21, 7
    s_lshl_b32 s21, s21, 10
    s_add_u32 s21, s21, s25
    buffer_load_dwordx4 v1, s[32:35], s21 offen sc1 lds
    s_add_u32 m0, s22, 1024
    s_mov_b32 s21, 1
    s_and_b32 s21, s21, 7
    s_lshl_b32 s21, s21, 10
    s_add_u32 s21, s21, s25
    buffer_load_dwordx4 v1, s[32:35], s21 offen sc1 lds
    s_add_u32 m0, s22, 2048
    s_mov_b32 s21, 2
    s_and_b32 s21, s21, 7
    s_lshl_b32 s21, s21, 10
    s_add_u32 s21, s21, s25
    buffer_load_dwordx4 v1, s[32:35], s21 offen sc1 lds
    s_add_u32 m0, s22, 3072
    s_mov_b32 s21, 3
    s_and_b32 s21, s21, 7
    s_lshl_b32 s21, s21, 10
    s_add_u32 s21, s21, s25
    buffer_load_dwordx4 v1, s[32:35], s21 offen sc1 lds
    s_add_u32 m0, s22, 4096
    s_mov_b32 s21, 4
    s_and_b32 s21, s21, 7
    s_lshl_b32 s21, s21, 10
    s_add_u32 s21, s21, s25
    buffer_load_dwordx4 v1, s[32:35], s21 offen sc1 lds
    s_add_u32 m0, s22, 5120
    s_mov_b32 s21, 5
    s_and_b32 s21, s21, 7
    s_lshl_b32 s21, s21, 10
    s_add_u32 s21, s21, s25
    buffer_load_dwordx4 v1, s[32:35], s21 offen sc1 lds
    s_add_u32 m0, s22, 6144
    s_mov_b32 s21, 6
    s_and_b32 s21, s21, 7
    s_lshl_b32 s21, s21, 10
    s_add_u32 s21, s21, s25
    buffer_load_dwordx4 v1, s[32:35], s21 offen sc1 lds
    s_add_u32 m0, s22, 7168
    s_mov_b32 s21, 7
    s_and_b32 s21, s21, 7
    s_lshl_b32 s21, s21, 10
    s_add_u32 s21, s21, s25
    buffer_load_dwordx4 v1, s[32:35], s21 offen sc1 lds
    s_lshl_b32 s25, s7, 10
    s_add_u32 s25, s25, s24
    s_add_u32 m0, s22, 8192
    s_add_u32 s25, s25, 32768
    buffer_load_dwordx4 v1, s[32:35], s25 offen sc1 lds
S_W2:
    s_waitcnt vmcnt(13)
    v_mfma_f32_32x32x16_bf16 v[16:31], v[96:99], v[104:107], v[16:31]
    v_mfma_f32_32x32x16_bf16 v[48:63], v[100:103], v[104:107], v[48:63]
    v_mfma_f32_32x32x16_bf16 v[32:47], v[96:99], v[108:111], v[32:47]
    v_mfma_f32_32x32x16_bf16 v[64:79], v[100:103], v[108:111], v[64:79]
    s_cmp_eq_u32 s31, 0
    s_cbranch_scc1 S_E_110
    v_mfma_f32_32x32x16_bf16 v[80:95], v[96:99], v[112:115], v[80:95]
S_E_110:
    s_add_u32 m0, s9, 15360
    s_mov_b32 s21, 6
    s_and_b32 s21, s21, 7
    s_lshl_b32 s21, s21, 10
    s_add_u32 s21, s21, s11
    buffer_load_dwordx4 v1, s[32:35], s21 offen sc1 lds
    s_waitcnt vmcnt(8)
    v_mfma_f32_32x32x16_bf16 v[16:31], v[116:119], v[124:127], v[16:31]
    v_mfma_f32_32x32x16_bf16 v[48:63], v[120:123], v[124:127], v[48:63]
    v_mfma_f32_32x32x16_bf16 v[32:47], v[116:119], v[128:131], v[32:47]
    v_mfma_f32_32x32x16_bf16 v[64:79], v[120:123], v[128:131], v[64:79]
    s_cmp_eq_u32 s31, 0
    s_cbranch_scc1 S_E_111
    v_mfma_f32_32x32x16_bf16 v[80:95], v[116:119], v[132:135], v[80:95]
S_E_111:
    s_add_u32 m0, s9, 16384
    s_mov_b32 s21, 7
    s_and_b32 s21, s21, 7
    s_lshl_b32 s21, s21, 10
    s_add_u32 s21, s21, s11
    buffer_load_dwordx4 v1, s[32:35], s21 offen sc1 lds
    s_waitcnt vmcnt(3)
    v_mfma_f32_32x32x16_bf16 v[16:31], v[136:139], v[144:147], v[16:31]
    v_mfma_f32_32x32x16_bf16 v[48:63], v[140:143], v[144:147], v[48:63]
    v_mfma_f32_32x32x16_bf16 v[32:47], v[136:139], v[148:151], v[32:47]
    v_mfma_f32_32x32x16_bf16 v[64:79], v[140:143], v[148:151], v[64:79]
    s_cmp_eq_u32 s31, 0
    s_cbranch_scc1 S_E_112
    v_mfma_f32_32x32x16_bf16 v[80:95], v[136:139], v[152:155], v[80:95]
S_E_112:
    s_add_u32 m0, s9, 17408
    s_add_u32 s21, s11, s17
    buffer_load_dwordx4 v1, s[32:35], s21 offen sc1 lds
    s_setprio 3
    v_and_b32 v12, 31, v0
    v_lshrrev_b32 v13, 5, v0
    v_lshlrev_b32 v14, 6, v13
    v_bfe_u32 v7, v0, 3, 1
    v_lshrrev_b32 v6, 4, v0
    v_lshl_add_u32 v7, v7, 4, v6
    v_mul_u32_u24 v7, 2304, v7
    v_and_b32 v6, 7, v0
    v_lshl_add_u32 v7, v6, 4, v7
    v_lshlrev_b32 v6, 9, v13
    v_lshl_add_u32 v6, v12, 2, v6
    s_mul_i32 s19, s27, 73728
    s_lshl_b32 s18, s29, 7
    s_add_u32 s19, s19, s18
    s_mul_i32 s21, s23, 73728
    s_lshl_b32 s18, s30, 7
    s_add_u32 s21, s21, s18
    s_mul_i32 s18, s7, 9216
    s_add_u32 s21, s21, s18
    s_and_b32 s24, s23, 1
    s_lshl_b32 s24, s24, 7
    s_add_u32 s24, s24, 161792
    v_add_u32 v14, s24, v14
    v_xor_b32 v15, 0x80, v14
SP_113:
    ds_read_b32 v4, v2 offset:88
    s_waitcnt lgkmcnt(0)
    v_readfirstlane_b32 s24, v4
    s_cmp_ge_u32 s24, 1
    s_cbranch_scc1 SD_114
    s_sleep 1
    s_sub_u32 s72, s72, 1
    s_cbranch_scc0 SP_113
    s_mov_b32 s72, 0
SD_114:
    ds_read_b128 v[96:99], v14 offset:0
    ds_read_b128 v[112:115], v15 offset:0
    ds_read_b128 v[100:103], v14 offset:16
    ds_read_b128 v[116:119], v15 offset:16
    ds_read_b128 v[104:107], v14 offset:32
    ds_read_b128 v[120:123], v15 offset:32
    ds_read_b128 v[108:111], v14 offset:48
    ds_read_b128 v[124:127], v15 offset:48
    s_lshl_b32 s24, s23, 5
    s_lshl_b32 s25, s7, 3
    s_add_u32 s24, s24, s25
    s_xor_b32 s25, s24, 32
    s_lshl_b32 s12, s24, 10
    s_add_u32 s12, s12, 9437184
    s_lshl_b32 s13, s25, 10
    s_add_u32 s13, s13, 9437184
    s_lshl_b32 s14, s24, 7
    s_add_u32 s14, s14, 65536
    s_lshl_b32 s15, s25, 7
    s_add_u32 s15, s15, 65536
    s_lshl_b32 s18, s4, 10
    s_lshl_b32 s25, s7, 8
    s_add_u32 s18, s18, s25
    s_add_u32 s18, s18, 327680
    s_mov_b32 s76, s66
    s_mov_b32 s77, s67
    s_mov_b32 s78, 4718592
    s_mov_b32 s79, 0x20000
SP_115:
    ds_read_b32 v4, v2 offset:36
    s_waitcnt lgkmcnt(0)
    v_readfirstlane_b32 s24, v4
    s_and_b32 s24, s24, 0xff
    s_cmp_ge_u32 s24, 8
    s_cbranch_scc1 SD_116
    s_sleep 4
    s_sub_u32 s72, s72, 1
    s_cbranch_scc0 SP_115
    s_mov_b32 s72, 0
SD_116:
    s_setprio 0
    s_mov_b64 exec, 3
    buffer_load_dword v10, v5, s[32:35], s18 offen sc1
    s_mov_b64 exec, -1
    v_mul_f32 v16, v16, v96
    v_mul_f32 v17, v17, v97
    v_mul_f32 v18, v18, v98
    v_mul_f32 v19, v19, v99
    v_mul_f32 v20, v20, v100
    v_mul_f32 v21, v21, v101
    v_mul_f32 v22, v22, v102
    v_mul_f32 v23, v23, v103
    v_mul_f32 v24, v24, v104
    v_mul_f32 v25, v25, v105
    v_mul_f32 v26, v26, v106
    v_mul_f32 v27, v27, v107
    v_mul_f32 v28, v28, v108
    v_mul_f32 v29, v29, v109
    v_mul_f32 v30, v30, v110
    v_mul_f32 v31, v31, v111
    v_mul_f32 v32, v32, v96
    v_mul_f32 v33, v33, v97
    v_mul_f32 v34, v34, v98
    v_mul_f32 v35, v35, v99
    v_mul_f32 v36, v36, v100
    v_mul_f32 v37, v37, v101
    v_mul_f32 v38, v38, v102
    v_mul_f32 v39, v39, v103
    v_mul_f32 v40, v40, v104
    v_mul_f32 v41, v41, v105
    v_mul_f32 v42, v42, v106
    v_mul_f32 v43, v43, v107
    v_mul_f32 v44, v44, v108
    v_mul_f32 v45, v45, v109
    v_mul_f32 v46, v46, v110
    v_mul_f32 v47, v47, v111
    v_mul_f32 v48, v48, v112
    v_mul_f32 v49, v49, v113
    v_mul_f32 v50, v50, v114
    v_mul_f32 v51, v51, v115
    v_mul_f32 v52, v52, v116
    v_mul_f32 v53, v53, v117
    v_mul_f32 v54, v54, v118
    v_mul_f32 v55, v55, v119
    v_mul_f32 v56, v56, v120
    v_mul_f32 v57, v57, v121
    v_mul_f32 v58, v58, v122
    v_mul_f32 v59, v59, v123
    v_mul_f32 v60, v60, v124
    v_mul_f32 v61, v61, v125
    v_mul_f32 v62, v62, v126
    v_mul_f32 v63, v63, v127
    v_mul_f32 v64, v64, v112
    v_mul_f32 v65, v65, v113
    v_mul_f32 v66, v66, v114
    v_mul_f32 v67, v67, v115
    v_mul_f32 v68, v68, v116
    v_mul_f32 v69, v69, v117
    v_mul_f32 v70, v70, v118
    v_mul_f32 v71, v71, v119
    v_mul_f32 v72, v72, v120
    v_mul_f32 v73, v73, v121
    v_mul_f32 v74, v74, v122
    v_mul_f32 v75, v75, v123
    v_mul_f32 v76, v76, v124
    v_mul_f32 v77, v77, v125
    v_mul_f32 v78, v78, v126
    v_mul_f32 v79, v79, v127
    s_cmp_eq_u32 s31, 0
    s_cbranch_scc1 S_Z2
    v_mul_f32 v80, v80, v96
    v_mul_f32 v81, v81, v97
    v_mul_f32 v82, v82, v98
    v_mul_f32 v83, v83, v99
    v_mul_f32 v84, v84, v100
    v_mul_f32 v85, v85, v101
    v_mul_f32 v86, v86, v102
    v_mul_f32 v87, v87, v103
    v_mul_f32 v88, v88, v104
    v_mul_f32 v89, v89, v105
    v_mul_f32 v90, v90, v106
    v_mul_f32 v91, v91, v107
    v_mul_f32 v92, v92, v108
    v_mul_f32 v93, v93, v109
    v_mul_f32 v94, v94, v110
    v_mul_f32 v95, v95, v111
S_Z2:
    s_mov_b64 exec, 3
    s_waitcnt vmcnt(0)
    s_branch PL_117_c
PL_117:
    buffer_load_dword v10, v5, s[32:35], s18 offen sc1
    s_waitcnt vmcnt(0)
PL_117_c:
    v_xor_b32 v4, s73, v10
    v_cmp_ne_u32 vcc, 0, v4
    s_cbranch_vccz PD_118
    s_mov_b64 exec, vcc
    s_sleep 4
    s_sub_u32 s72, s72, 1
    s_cbranch_scc0 PL_117
    s_mov_b32 s72, 0
PD_118:
    s_mov_b64 exec, -1
    s_mov_b32 s24, 0
    s_and_b32 s24, s24, 7
    s_lshl_b32 s24, s24, 10
    s_add_u32 s25, s24, s12
    s_add_u32 s24, s24, s13
    buffer_load_dwordx4 v[96:99], v1, s[32:35], s25 offen sc1
    buffer_load_dwordx4 v[100:103], v1, s[32:35], s24 offen sc1
    s_mov_b32 s24, 1
    s_and_b32 s24, s24, 7
    s_lshl_b32 s24, s24, 10
    s_add_u32 s25, s24, s12
    s_add_u32 s24, s24, s13
    buffer_load_dwordx4 v[104:107], v1, s[32:35], s25 offen sc1
    buffer_load_dwordx4 v[108:111], v1, s[32:35], s24 offen sc1
    s_mov_b32 s24, 2
    s_and_b32 s24, s24, 7
    s_lshl_b32 s24, s24, 10
    s_add_u32 s25, s24, s12
    s_add_u32 s24, s24, s13
    buffer_load_dwordx4 v[112:115], v1, s[32:35], s25 offen sc1
    buffer_load_dwordx4 v[116:119], v1, s[32:35], s24 offen sc1
    s_mov_b32 s24, 3
    s_and_b32 s24, s24, 7
    s_lshl_b32 s24, s24, 10
    s_add_u32 s25, s24, s12
    s_add_u32 s24, s24, s13
    buffer_load_dwordx4 v[120:123], v1, s[32:35], s25 offen sc1
    buffer_load_dwordx4 v[124:127], v1, s[32:35], s24 offen sc1
    s_mov_b32 s24, 4
    s_and_b32 s24, s24, 7
    s_lshl_b32 s24, s24, 10
    s_add_u32 s25, s24, s12
    s_add_u32 s24, s24, s13
    buffer_load_dwordx4 v[128:131], v1, s[32:35], s25 offen sc1
    buffer_load_dwordx4 v[132:135], v1, s[32:35], s24 offen sc1
    s_mov_b32 s24, 5
    s_and_b32 s24, s24, 7
    s_lshl_b32 s24, s24, 10
    s_add_u32 s25, s24, s12
    s_add_u32 s24, s24, s13
    buffer_load_dwordx4 v[136:139], v1, s[32:35], s25 offen sc1
    buffer_load_dwordx4 v[140:143], v1, s[32:35], s24 offen sc1
    s_mov_b32 s24, 6
    s_and_b32 s24, s24, 7
    s_lshl_b32 s24, s24, 10
    s_add_u32 s25, s24, s12
    s_add_u32 s24, s24, s13
    buffer_load_dwordx4 v[144:147], v1, s[32:35], s25 offen sc1
    buffer_load_dwordx4 v[148:151], v1, s[32:35], s24 offen sc1
SP_119:
    ds_read_b32 v4, v2 offset:108
    s_waitcnt lgkmcnt(0)
    v_readfirstlane_b32 s24, v4
    s_cmp_ge_u32 s24, 8
    s_cbranch_scc1 SD_120
    s_sleep 1
    s_sub_u32 s72, s72, 1
    s_cbranch_scc0 SP_119
    s_mov_b32 s72, 0
SD_120:
    ds_read_b128 v[152:155], v8 offset:0
    ds_read_b128 v[156:159], v8 offset:9216
    ds_read_b128 v[12:15], v9 offset:0
    ds_read_b128 v[160:163], v8 offset:1024
    ds_read_b128 v[164:167], v8 offset:10240
    s_waitcnt vmcnt(12)
    s_waitcnt lgkmcnt(2)
    v_mfma_f32_32x32x16_bf16 v[32:47], v[96:99], v[156:159], v[32:47]
    s_cmp_eq_u32 s31, 0
    s_cbranch_scc1 S_E_121
    v_mfma_f32_32x32x16_bf16 v[80:95], v[96:99], v[12:15], v[80:95]
S_E_121:
    ds_read_b128 v[12:15], v9 offset:1024
    v_mfma_f32_32x32x16_bf16 v[48:63], v[100:103], v[152:155], v[48:63]
    v_mfma_f32_32x32x16_bf16 v[64:79], v[100:103], v[156:159], v[64:79]
    v_mfma_f32_32x32x16_bf16 v[16:31], v[96:99], v[152:155], v[16:31]
    s_mov_b32 s24, 7
    s_and_b32 s24, s24, 7
    s_lshl_b32 s24, s24, 10
    s_add_u32 s25, s24, s12
    s_add_u32 s24, s24, s13
    buffer_load_dwordx4 v[96:99], v1, s[32:35], s25 offen sc1
    buffer_load_dwordx4 v[100:103], v1, s[32:35], s24 offen sc1
    ds_read_b128 v[152:155], v8 offset:2048
    ds_read_b128 v[156:159], v8 offset:11264
    s_waitcnt vmcnt(12)
    s_waitcnt lgkmcnt(2)
    v_mfma_f32_32x32x16_bf16 v[32:47], v[104:107], v[164:167], v[32:47]
    s_cmp_eq_u32 s31, 0
    s_cbranch_scc1 S_E_122
    v_mfma_f32_32x32x16_bf16 v[80:95], v[104:107], v[12:15], v[80:95]
S_E_122:
    ds_read_b128 v[12:15], v9 offset:2048
    v_mfma_f32_32x32x16_bf16 v[48:63], v[108:111], v[160:163], v[48:63]
    v_mfma_f32_32x32x16_bf16 v[64:79], v[108:111], v[164:167], v[64:79]
    v_mfma_f32_32x32x16_bf16 v[16:31], v[104:107], v[160:163], v[16:31]
    buffer_load_dword v104, v6, s[32:35], s14 offen offset:0 sc1
    buffer_load_dword v105, v6, s[32:35], s14 offen offset:128 sc1
    buffer_load_dword v106, v6, s[32:35], s14 offen offset:256 sc1
    buffer_load_dword v107, v6, s[32:35], s14 offen offset:384 sc1
    buffer_load_dword v108, v6, s[32:35], s15 offen offset:0 sc1
    buffer_load_dword v109, v6, s[32:35], s15 offen offset:128 sc1
    buffer_load_dword v110, v6, s[32:35], s15 offen offset:256 sc1
    buffer_load_dword v111, v6, s[32:35], s15 offen offset:384 sc1
    ds_read_b128 v[160:163], v8 offset:3072
    ds_read_b128 v[164:167], v8 offset:12288
    s_waitcnt vmcnt(18)
    s_waitcnt lgkmcnt(2)
    v_mfma_f32_32x32x16_bf16 v[32:47], v[112:115], v[156:159], v[32:47]
    s_cmp_eq_u32 s31, 0
    s_cbranch_scc1 S_E_123
    v_mfma_f32_32x32x16_bf16 v[80:95], v[112:115], v[12:15], v[80:95]
S_E_123:
    ds_read_b128 v[12:15], v9 offset:3072
    v_mfma_f32_32x32x16_bf16 v[48:63], v[116:119], v[152:155], v[48:63]
    v_mfma_f32_32x32x16_bf16 v[64:79], v[116:119], v[156:159], v[64:79]
    v_mfma_f32_32x32x16_bf16 v[16:31], v[112:115], v[152:155], v[16:31]
    ds_read_b128 v[152:155], v8 offset:4096
    ds_read_b128 v[156:159], v8 offset:13312
    s_waitcnt vmcnt(16)
    s_waitcnt lgkmcnt(2)
    v_mfma_f32_32x32x16_bf16 v[32:47], v[120:123], v[164:167], v[32:47]
    s_cmp_eq_u32 s31, 0
    s_cbranch_scc1 S_E_124
    v_mfma_f32_32x32x16_bf16 v[80:95], v[120:123], v[12:15], v[80:95]
S_E_124:
    ds_read_b128 v[12:15], v9 offset:4096
    v_mfma_f32_32x32x16_bf16 v[48:63], v[124:127], v[160:163], v[48:63]
    v_mfma_f32_32x32x16_bf16 v[64:79], v[124:127], v[164:167], v[64:79]
    v_mfma_f32_32x32x16_bf16 v[16:31], v[120:123], v[160:163], v[16:31]
    ds_read_b128 v[160:163], v8 offset:5120
    ds_read_b128 v[164:167], v8 offset:14336
    s_waitcnt vmcnt(14)
    s_waitcnt lgkmcnt(2)
    v_mfma_f32_32x32x16_bf16 v[32:47], v[128:131], v[156:159], v[32:47]
    s_cmp_eq_u32 s31, 0
    s_cbranch_scc1 S_E_125
    v_mfma_f32_32x32x16_bf16 v[80:95], v[128:131], v[12:15], v[80:95]
S_E_125:
    ds_read_b128 v[12:15], v9 offset:5120
    v_mfma_f32_32x32x16_bf16 v[48:63], v[132:135], v[152:155], v[48:63]
    v_mfma_f32_32x32x16_bf16 v[64:79], v[132:135], v[156:159], v[64:79]
    v_mfma_f32_32x32x16_bf16 v[16:31], v[128:131], v[152:155], v[16:31]
    s_waitcnt vmcnt(12)
    s_waitcnt lgkmcnt(0)
    ds_read_b128 v[112:115], v8 offset:6144
    ds_read_b128 v[116:119], v8 offset:7168
    ds_read_b128 v[120:123], v8 offset:8192
    ds_read_b128 v[124:127], v8 offset:15360
    ds_read_b128 v[128:131], v8 offset:16384
    ds_read_b128 v[132:135], v8 offset:17408
    v_mfma_f32_32x32x16_bf16 v[32:47], v[136:139], v[164:167], v[32:47]
    s_cmp_eq_u32 s31, 0
    s_cbranch_scc1 S_E_126
    v_mfma_f32_32x32x16_bf16 v[80:95], v[136:139], v[12:15], v[80:95]
S_E_126:
    v_mfma_f32_32x32x16_bf16 v[48:63], v[140:143], v[160:163], v[48:63]
    v_mfma_f32_32x32x16_bf16 v[64:79], v[140:143], v[164:167], v[64:79]
    v_mfma_f32_32x32x16_bf16 v[16:31], v[136:139], v[160:163], v[16:31]
    ds_read_b128 v[136:139], v9 offset:6144
    ds_read_b128 v[140:143], v9 offset:7168
    ds_read_b128 v[12:15], v9 offset:8192
    s_lshl_b32 s24, s7, 12
    s_add_u32 s24, s24, 19456
    v_add_u32 v152, s24, v1
    s_lshl_b32 s24, s7, 10
    s_add_u32 s24, s24, 115712
    v_add_u32 v153, s24, v1
    s_and_b32 s24, s7, 1
    s_lshl_b32 s24, s24, 12
    s_sub_u32 s25, s9, 19456
    s_add_u32 s12, s25, s24
    s_xor_b32 s24, s24, 0x1000
    s_add_u32 s13, s25, s24
    s_lshl_b32 s14, s7, 12
    s_add_u32 s14, s14, 58368
    s_waitcnt vmcnt(10)
    s_waitcnt vmcnt(8)
    s_waitcnt vmcnt(0)
    s_waitcnt vmcnt(0) lgkmcnt(0)
    v_mfma_f32_32x32x16_bf16 v[32:47], v[144:147], v[124:127], v[32:47]
    v_mfma_f32_32x32x16_bf16 v[32:47], v[96:99], v[128:131], v[32:47]
    v_mfma_f32_32x32x16_bf16 v[32:47], v[104:107], v[132:135], v[32:47]
    v_mfma_f32_32x32x16_bf16 v[64:79], v[148:151], v[124:127], v[64:79]
    v_mfma_f32_32x32x16_bf16 v[64:79], v[100:103], v[128:131], v[64:79]
    v_mfma_f32_32x32x16_bf16 v[64:79], v[108:111], v[132:135], v[64:79]
    v_mfma_f32_32x32x16_bf16 v[16:31], v[144:147], v[112:115], v[16:31]
    s_mov_b32 m0, s13
    s_nop 6
    ds_write_addtid_b32 v32 offset:19456
    ds_write_addtid_b32 v33 offset:19712
    ds_write_addtid_b32 v34 offset:19968
    ds_write_addtid_b32 v35 offset:20224
    v_mfma_f32_32x32x16_bf16 v[16:31], v[96:99], v[116:119], v[16:31]
    ds_write_addtid_b32 v36 offset:20480
    ds_write_addtid_b32 v37 offset:20736
    ds_write_addtid_b32 v38 offset:20992
    ds_write_addtid_b32 v39 offset:21248
    ds_write_addtid_b32 v40 offset:21504
    ds_write_addtid_b32 v41 offset:21760
    v_mfma_f32_32x32x16_bf16 v[16:31], v[104:107], v[120:123], v[16:31]
    ds_write_addtid_b32 v42 offset:22016
    ds_write_addtid_b32 v43 offset:22272
    ds_write_addtid_b32 v44 offset:22528
    ds_write_addtid_b32 v45 offset:22784
    ds_write_addtid_b32 v46 offset:23040
    ds_write_addtid_b32 v47 offset:23296
    v_mfma_f32_32x32x16_bf16 v[48:63], v[148:151], v[112:115], v[48:63]
    ds_write_addtid_b32 v64 offset:27648
    ds_write_addtid_b32 v65 offset:27904
    ds_write_addtid_b32 v66 offset:28160
    ds_write_addtid_b32 v67 offset:28416
    ds_write_addtid_b32 v68 offset:28672
    v_mfma_f32_32x32x16_bf16 v[48:63], v[100:103], v[116:119], v[48:63]
    ds_write_addtid_b32 v69 offset:28928
    ds_write_addtid_b32 v70 offset:29184
    ds_write_addtid_b32 v71 offset:29440
    ds_write_addtid_b32 v72 offset:29696
    ds_write_addtid_b32 v73 offset:29952
    v_mfma_f32_32x32x16_bf16 v[48:63], v[108:111], v[120:123], v[48:63]
    ds_write_addtid_b32 v74 offset:30208
    ds_write_addtid_b32 v75 offset:30464
    ds_write_addtid_b32 v76 offset:30720
    ds_write_addtid_b32 v77 offset:30976
    ds_write_addtid_b32 v78 offset:31232
    ds_write_addtid_b32 v79 offset:31488
    s_mov_b32 m0, s12
    s_cmp_eq_u32 s31, 0
    s_cbranch_scc1 S_R0
    v_mfma_f32_32x32x16_bf16 v[80:95], v[144:147], v[136:139], v[80:95]
    ds_write_addtid_b32 v16 offset:19456
    ds_write_addtid_b32 v17 offset:19712
    ds_write_addtid_b32 v18 offset:19968
    ds_write_addtid_b32 v19 offset:20224
    ds_write_addtid_b32 v20 offset:20480
    v_mfma_f32_32x32x16_bf16 v[80:95], v[96:99], v[140:143], v[80:95]
    ds_write_addtid_b32 v21 offset:20736
    ds_write_addtid_b32 v22 offset:20992
    ds_write_addtid_b32 v23 offset:21248
    ds_write_addtid_b32 v24 offset:21504
    ds_write_addtid_b32 v25 offset:21760
    v_mfma_f32_32x32x16_bf16 v[80:95], v[104:107], v[12:15], v[80:95]
    ds_write_addtid_b32 v26 offset:22016
    ds_write_addtid_b32 v27 offset:22272
    ds_write_addtid_b32 v28 offset:22528
    ds_write_addtid_b32 v29 offset:22784
    ds_write_addtid_b32 v30 offset:23040
    ds_write_addtid_b32 v31 offset:23296
    ds_write_addtid_b32 v48 offset:27648
    ds_write_addtid_b32 v49 offset:27904
    ds_write_addtid_b32 v50 offset:28160
    ds_write_addtid_b32 v51 offset:28416
    ds_write_addtid_b32 v52 offset:28672
    ds_write_addtid_b32 v53 offset:28928
    ds_write_addtid_b32 v54 offset:29184
    ds_write_addtid_b32 v55 offset:29440
    ds_write_addtid_b32 v56 offset:29696
    ds_write_addtid_b32 v57 offset:29952
    ds_write_addtid_b32 v58 offset:30208
    ds_write_addtid_b32 v59 offset:30464
    ds_write_addtid_b32 v60 offset:30720
    ds_write_addtid_b32 v61 offset:30976
    ds_write_addtid_b32 v62 offset:31232
    ds_write_addtid_b32 v63 offset:31488
    s_mov_b32 m0, s14
    s_nop 0
    ds_write_addtid_b32 v80 offset:57344
    ds_write_addtid_b32 v81 offset:57600
    ds_write_addtid_b32 v82 offset:57856
    ds_write_addtid_b32 v83 offset:58112
    ds_write_addtid_b32 v84 offset:58368
    ds_write_addtid_b32 v85 offset:58624
    ds_write_addtid_b32 v86 offset:58880
    ds_write_addtid_b32 v87 offset:59136
    ds_write_addtid_b32 v88 offset:59392
    ds_write_addtid_b32 v89 offset:59648
    ds_write_addtid_b32 v90 offset:59904
    ds_write_addtid_b32 v91 offset:60160
    ds_write_addtid_b32 v92 offset:60416
    ds_write_addtid_b32 v93 offset:60672
    ds_write_addtid_b32 v94 offset:60928
    ds_write_addtid_b32 v95 offset:61184
    s_branch S_R1
S_R0:
    ds_write_addtid_b32 v16 offset:19456
    ds_write_addtid_b32 v17 offset:19712
    ds_write_addtid_b32 v18 offset:19968
    ds_write_addtid_b32 v19 offset:20224
    ds_write_addtid_b32 v20 offset:20480
    ds_write_addtid_b32 v21 offset:20736
    ds_write_addtid_b32 v22 offset:20992
    ds_write_addtid_b32 v23 offset:21248
    ds_write_addtid_b32 v24 offset:21504
    ds_write_addtid_b32 v25 offset:21760
    ds_write_addtid_b32 v26 offset:22016
    ds_write_addtid_b32 v27 offset:22272
    ds_write_addtid_b32 v28 offset:22528
    ds_write_addtid_b32 v29 offset:22784
    ds_write_addtid_b32 v30 offset:23040
    ds_write_addtid_b32 v31 offset:23296
    ds_write_addtid_b32 v48 offset:27648
    ds_write_addtid_b32 v49 offset:27904
    ds_write_addtid_b32 v50 offset:28160
    ds_write_addtid_b32 v51 offset:28416
    ds_write_addtid_b32 v52 offset:28672
    ds_write_addtid_b32 v53 offset:28928
    ds_write_addtid_b32 v54 offset:29184
    ds_write_addtid_b32 v55 offset:29440
    ds_write_addtid_b32 v56 offset:29696
    ds_write_addtid_b32 v57 offset:29952
    ds_write_addtid_b32 v58 offset:30208
    ds_write_addtid_b32 v59 offset:30464
    ds_write_addtid_b32 v60 offset:30720
    ds_write_addtid_b32 v61 offset:30976
    ds_write_addtid_b32 v62 offset:31232
    ds_write_addtid_b32 v63 offset:31488
S_R1:
    s_waitcnt lgkmcnt(0)
    s_barrier
    ds_read_b128 v[16:19], v152 offset:0
    ds_read_b128 v[20:23], v152 offset:18432
    ds_read_b128 v[24:27], v152 offset:36864
    ds_read_b128 v[28:31], v152 offset:55296
    ds_read_b128 v[32:35], v152 offset:1024
    ds_read_b128 v[36:39], v152 offset:19456
    ds_read_b128 v[40:43], v152 offset:37888
    ds_read_b128 v[44:47], v152 offset:56320
    ds_read_b128 v[48:51], v152 offset:2048
    ds_read_b128 v[52:55], v152 offset:20480
    ds_read_b128 v[56:59], v152 offset:38912
    ds_read_b128 v[60:63], v152 offset:57344
    s_waitcnt lgkmcnt(8)
    ds_read_b128 v[64:67], v152 offset:3072
    ds_read_b128 v[68:71], v152 offset:21504
    ds_read_b128 v[72:75], v152 offset:39936
    ds_read_b128 v[76:79], v152 offset:58368
    v_add_f32 v16, v16, v20
    v_add_f32 v24, v24, v28
    v_add_f32 v17, v17, v21
    v_add_f32 v25, v25, v29
    v_add_f32 v18, v18, v22
    v_add_f32 v26, v26, v30
    v_add_f32 v19, v19, v23
    v_add_f32 v27, v27, v31
    v_add_f32 v16, v16, v24
    v_add_f32 v17, v17, v25
    v_add_f32 v18, v18, v26
    v_add_f32 v19, v19, v27
    buffer_store_dwordx4 v[16:19], v7, s[76:79], s19 offen sc1
    s_add_u32 s19, s19, 9216
    s_waitcnt lgkmcnt(8)
    ds_read_b128 v[80:83], v153 offset:0
    ds_read_b128 v[84:87], v153 offset:4096
    ds_read_b128 v[88:91], v153 offset:8192
    ds_read_b128 v[92:95], v153 offset:12288
    v_add_f32 v32, v32, v36
    v_add_f32 v40, v40, v44
    v_add_f32 v33, v33, v37
    v_add_f32 v41, v41, v45
    v_add_f32 v34, v34, v38
    v_add_f32 v42, v42, v46
    v_add_f32 v35, v35, v39
    v_add_f32 v43, v43, v47
    v_add_f32 v32, v32, v40
    v_add_f32 v33, v33, v41
    v_add_f32 v34, v34, v42
    v_add_f32 v35, v35, v43
    buffer_store_dwordx4 v[32:35], v7, s[76:79], s19 offen sc1
    s_add_u32 s19, s19, 9216
    s_waitcnt lgkmcnt(8)
    v_add_f32 v48, v48, v52
    v_add_f32 v56, v56, v60
    v_add_f32 v49, v49, v53
    v_add_f32 v57, v57, v61
    v_add_f32 v50, v50, v54
    v_add_f32 v58, v58, v62
    v_add_f32 v51, v51, v55
    v_add_f32 v59, v59, v63
    v_add_f32 v48, v48, v56
    v_add_f32 v49, v49, v57
    v_add_f32 v50, v50, v58
    v_add_f32 v51, v51, v59
    buffer_store_dwordx4 v[48:51], v7, s[76:79], s19 offen sc1
    s_add_u32 s19, s19, 9216
    s_waitcnt lgkmcnt(4)
    v_add_f32 v64, v64, v68
    v_add_f32 v72, v72, v76
    v_add_f32 v65, v65, v69
    v_add_f32 v73, v73, v77
    v_add_f32 v66, v66, v70
    v_add_f32 v74, v74, v78
    v_add_f32 v67, v67, v71
    v_add_f32 v75, v75, v79
    v_add_f32 v64, v64, v72
    v_add_f32 v65, v65, v73
    v_add_f32 v66, v66, v74
    v_add_f32 v67, v67, v75
    buffer_store_dwordx4 v[64:67], v7, s[76:79], s19 offen sc1
    s_cmp_eq_u32 s31, 0
    s_cbranch_scc1 F_END
    s_waitcnt lgkmcnt(0)
    v_add_f32 v80, v80, v84
    v_add_f32 v88, v88, v92
    v_add_f32 v81, v81, v85
    v_add_f32 v89, v89, v93
    v_add_f32 v82, v82, v86
    v_add_f32 v90, v90, v94
    v_add_f32 v83, v83, v87
    v_add_f32 v91, v91, v95
    v_add_f32 v80, v80, v88
    v_add_f32 v81, v81, v89
    v_add_f32 v82, v82, v90
    v_add_f32 v83, v83, v91
    buffer_store_dwordx4 v[80:83], v7, s[76:79], s21 offen sc1
    s_branch F_END
F_END:
    s_endpgm
F_EXIT:
    s_endpgm
.section .rodata,"a"
.p2align 6
.amdhsa_kernel gated_mix__ssm_conv_s5__grouped_kv_mqa__prompt_kernel
  .amdhsa_next_free_vgpr 168
  .amdhsa_next_free_sgpr 102
  .amdhsa_accum_offset 168
  .amdhsa_group_segment_fixed_size 0
  .amdhsa_kernarg_size 144
  .amdhsa_user_sgpr_count 2
  .amdhsa_user_sgpr_kernarg_segment_ptr 1
  .amdhsa_system_sgpr_workgroup_id_x 1
  .amdhsa_float_denorm_mode_32 3
.end_amdhsa_kernel
```
